```python
import torch

def _softmax(x, axis=-1):
    return torch.softmax(x, dim=axis)
def _gelu(x):
    return torch.nn.functional.gelu(x, approximate="tanh")
def _silu(x):
    return torch.nn.functional.silu(x)
def _sigmoid(x):
    return torch.sigmoid(x)
def _layernorm(x, axis=-1, eps=1e-5):
    m = x.mean(dim=axis, keepdim=True)
    v = x.var(dim=axis, keepdim=True, unbiased=False)
    return (x - m) / torch.sqrt(v + eps)
def _scatter_add(tgt, idx, src, axis=0):
    return tgt.clone().index_add_(axis, idx, src)
def _segment_sum(src, seg, n):
    out = torch.zeros((n,) + src.shape[1:], dtype=src.dtype)
    return out.index_add_(0, seg, src)
def _pad(x, pw):
    flat = tuple(v for pair in reversed(pw) for v in pair)
    return torch.nn.functional.pad(x, flat)

kernel_name = 'concat_heads__spectral_gfnet__ssm_conv_s4__prompt'

def setup_inputs():

    _w = (lambda a: (lambda t: t.to(torch.bfloat16) if t.is_floating_point() else t)(torch.as_tensor(a)))
    def _A_setup():
        B, S, D = 1, 2048, 512
        Df = D // 2 + 1
        return {
            "x": _w((lambda *s: torch.randn(*s, dtype=torch.bfloat16) * 0.05)(B, S, D)),
            "w_r": _w((lambda *s: torch.randn(*s, dtype=torch.bfloat16) * 0.8)(S, Df) * 0.02),
            "w_i": _w((lambda *s: torch.randn(*s, dtype=torch.bfloat16) * 0.8)(S, Df) * 0.02),
        }
    _A_in = _A_setup()

    def _B_setup():
        B, L, D, N = 1, 2048, 512, 128
        A_re = -(lambda _x: torch.exp(torch.as_tensor(_x)))((lambda *s: torch.randn(*s, dtype=torch.bfloat16) * 3.2)(D, N))
        A_im = torch.pi * (lambda *s: torch.randn(*s, dtype=torch.bfloat16) * 0.05)(D, N)
        B_re = (lambda *s: torch.randn(*s, dtype=torch.bfloat16) * 0.1)(D, N)
        B_im = (lambda *s: torch.randn(*s, dtype=torch.bfloat16) * 0.1)(D, N)
        C_re = (lambda *s: torch.randn(*s, dtype=torch.bfloat16) * 0.1)(D, N)
        C_im = (lambda *s: torch.randn(*s, dtype=torch.bfloat16) * 0.1)(D, N)
        log_dt = (lambda *s: torch.randn(*s, dtype=torch.bfloat16) * 0.05)(D) * 0.5 - 4.0
        Dskip = (lambda *s: torch.randn(*s, dtype=torch.bfloat16) * 0.05)(D)
        return {
            "u": _w((lambda *s: torch.randn(*s, dtype=torch.bfloat16) * 0.05)(B, L, D)),
            "A_re": _w(A_re),
            "A_im": _w(A_im),
            "B_re": _w(B_re),
            "B_im": _w(B_im),
            "C_re": _w(C_re),
            "C_im": _w(C_im),
            "log_dt": _w(log_dt),
            "Dskip": _w(Dskip),
        }
    _B_in = _B_setup()

    return {
        "A_x": _A_in["x"],
        "A_w_r": _A_in["w_r"],
        "A_w_i": _A_in["w_i"],
        "B_u": _B_in["u"],
        "B_A_re": _B_in["A_re"],
        "B_A_im": _B_in["A_im"],
        "B_B_re": _B_in["B_re"],
        "B_B_im": _B_in["B_im"],
        "B_C_re": _B_in["C_re"],
        "B_C_im": _B_in["C_im"],
        "B_log_dt": _B_in["log_dt"],
        "B_Dskip": _B_in["Dskip"],
    }

def reference(A_x, A_w_r, A_w_i, B_u, B_A_re, B_A_im, B_B_re, B_B_im, B_C_re, B_C_im, B_log_dt, B_Dskip):
    def _A_ref(x, w_r, w_i):
        B, S, D = x.shape
        X = (lambda x, axes=(-2,-1): torch.fft.rfft2(x.float(), dim=axes))(x, axes=(-2, -1))
        W = w_r + 1j * w_i
        X = X * W
        y = (lambda x, s, axes=(-2,-1): torch.fft.irfft2(x, s=s, dim=axes).to(torch.bfloat16))(X, (S, D), axes=(-2, -1))
        return y

    def _B_ref(u, A_re, A_im, B_re, B_im, C_re, C_im, log_dt, Dskip):
        Bsz, L, D = u.shape
        dt = torch.exp(log_dt)[:, None]
        A = A_re + 1j * A_im
        Bc = B_re + 1j * B_im
        Cc = C_re + 1j * C_im
        logdA = dt * A
        dB = dt * Bc
        l = (lambda x, dt: x.to(dt))(torch.arange(L), A_re.dtype)
        P = torch.exp(logdA[:, :, None] * l[None, None, :])
        K = torch.einsum("dn,dnl,dn->dl", Cc, P, dB).real
        L2 = 2 * L
        Kp = _pad(K, ((0, 0), (0, L)))
        up = (lambda x, *d: x.permute(*d))(u, 0, 2, 1)
        up = _pad(up, ((0, 0), (0, 0), (0, L)))
        Kf = (lambda x, axes=(-2,-1): torch.fft.rfft2(x.float(), dim=axes))(Kp[:, None, :], axes=(-2, -1))
        Uf = (lambda x, axes=(-2,-1): torch.fft.rfft2(x.float(), dim=axes))(up[:, :, None, :], axes=(-2, -1))
        Yf = Uf * Kf[None, :, :, :]
        y = (lambda x, s, axes=(-2,-1): torch.fft.irfft2(x, s=s, dim=axes).to(torch.bfloat16))(Yf, (1, L2), axes=(-2, -1))[:, :, 0, :L]
        y = (lambda x, *d: x.permute(*d))(y, 0, 2, 1) + u * Dskip[None, None, :]
        return y

    a = _A_ref(A_x, A_w_r, A_w_i)
    b = _B_ref(B_u, B_A_re, B_A_im, B_B_re, B_B_im, B_C_re, B_C_im, B_log_dt, B_Dskip)
    return torch.concatenate([a, b], axis=-1)
```

```asm
; @launch grid=(256,1,1) block=(512,1,1) lds=134912
.amdgcn_target "amdgcn-amd-amdhsa--gfx950"
.text
.globl concat_heads__spectral_gfnet__ssm_conv_s4__prompt_kernel
.p2align 8
.type concat_heads__spectral_gfnet__ssm_conv_s4__prompt_kernel,@function
concat_heads__spectral_gfnet__ssm_conv_s4__prompt_kernel:
    s_load_dwordx2 s[12:13], s[0:1], 0
    s_load_dwordx16 s[16:31], s[0:1], 24
    s_load_dwordx4 s[32:35], s[0:1], 88
    s_getpc_b64 s[8:9]
L_pc:
    v_and_b32 v204, 63, v0
    v_lshlrev_b32 v204, 9, v204
    s_cmp_ge_u32 s2, 256
    s_cbranch_scc1 L_exit
    v_and_b32 v205, 0x1c0, v0
    s_bitcmp1_b32 s2, 3
    s_cselect_b32 s4, L_B2-L_A, 0
    v_or_b32 v204, v204, v205
    s_add_u32 s4, s4, L_A-L_pc
    s_add_u32 s8, s8, s4
    s_addc_u32 s9, s9, 0
    s_movk_i32 s10, 3072
    s_mov_b32 s11, 0x20000
    buffer_load_dword v205, v204, s[8:11], 0 offen
    s_lshr_b32 s4, s2, 1
    s_and_b32 s4, s4, 120
    s_and_b32 s5, s2, 7
    s_or_b32 s4, s4, s5
    v_lshrrev_b32 v1, 6, v0
    v_and_b32 v2, 63, v0
    v_readfirstlane_b32 s3, v1
    v_lshlrev_b32 v3, 4, v2
    s_lshr_b32 s45, s4, 3
    s_lshl_b32 s46, s5, 6
    s_lshl_b32 s47, s45, 2
    s_add_u32 s46, s46, s47
    s_lshl_b32 s47, s46, 8
    v_lshl_add_u32 v39, v0, 1, s47
    s_mov_b32 s14, 2097152
    s_mov_b32 s15, 0x20000
    s_lshl_b32 s62, s4, 10
    s_lshl_b32 s63, s3, 18
    s_lshl_b32 s6, s3, 11
    s_add_u32 s62, s62, s63
    s_mov_b32 m0, s6
    s_add_u32 s63, s62, 0x20000
    v_lshrrev_b32 v84, 7, v39
    v_and_b32 v84, -2, v84
    s_bitcmp1_b32 s2, 3
    s_waitcnt lgkmcnt(0)
    s_cbranch_scc0 L_A
    global_load_ushort v10, v84, s[30:31]
    global_load_ushort v4, v39, s[18:19] nt
    global_load_ushort v5, v39, s[20:21] nt
    global_load_ushort v6, v39, s[22:23] nt
    global_load_ushort v7, v39, s[24:25] nt
    global_load_ushort v8, v39, s[26:27] nt
    global_load_ushort v9, v39, s[28:29] nt
    global_load_ushort v16, v84, s[32:33]
    s_branch L_B2
L_A:
    buffer_load_dwordx4 v3, s[12:15], s62 offen nt lds
    s_add_u32 m0, s6, 1024
    s_mov_b32 s2, s4
    buffer_load_dwordx4 v3, s[12:15], s63 offen nt lds
    s_load_dwordx2 s[20:21], s[0:1], 8
    s_load_dwordx2 s[24:25], s[0:1], 16
    s_load_dwordx2 s[28:29], s[0:1], 96
    s_load_dwordx2 s[32:33], s[0:1], 112
    s_lshl_b32 s62, s62, 1
    s_lshl_b32 s63, s63, 1
    s_mov_b32 s46, s6
    v_and_b32 v0, 63, v0
    v_and_b32 v1, 15, v0
    v_lshrrev_b32 v2, 4, v0
    s_mov_b32 s49, 0x3d800000
    v_cvt_f32_u32 v124, v1
    v_cvt_f32_u32 v126, v2
    v_mul_f32 v125, s49, v124
    v_mul_f32 v126, 4.0, v126
    s_and_b32 s47, s3, 3
    v_cvt_f32_u32 v24, s47
    s_lshl_b32 s47, s47, 2
    v_add_f32 v24, v24, v126
    v_add_u32 v27, s47, v3
    v_mul_f32 v24, v24, v125
    s_cmp_ge_u32 s3, 4
    s_cbranch_scc1 L_cs3
    v_fma_f32 v25, v125, 0.5, v24
    v_cos_f32 v108, v24
    v_sin_f32 v109, v24
    v_cos_f32 v110, v25
    v_sin_f32 v111, v25
    v_cmp_eq_u32 vcc, 0, v1
    v_mov_b32 v25, 0xbf803f80
    v_cvt_pk_bf16_f32 v108, v108, v110
    v_cvt_pk_bf16_f32 v109, -v109, -v111
    ds_write_b32 v27, v108 offset:35072
    v_cndmask_b32 v109, v109, v25, vcc
    ds_write_b32 v27, v109 offset:36096
    s_branch L_cs4
L_cs3:
    v_cvt_f32_u32 v25, s2
    v_mul_f32 v25, 0x3a000000, v25
    v_fmac_f32 v24, v25, v124
    v_cos_f32 v108, v24
    v_sin_f32 v109, v24
    s_nop 0
    v_cvt_pk_bf16_f32 v110, v108, v109
    v_cvt_pk_bf16_f32 v111, -v109, v108
    ds_write_b32 v27, v110 offset:37120
    ds_write_b32 v27, v111 offset:38144
L_cs4:
    s_mov_b32 s22, 1052672
    s_mov_b32 s23, 0x20000
    s_mov_b32 s26, 1052672
    s_mov_b32 s27, 0x20000
    s_mov_b32 s30, 4194304
    s_mov_b32 s31, 0x20000
    s_mov_b32 s34, 268435456
    s_mov_b32 s35, 0x20000
    s_mov_b32 s64, 0
    s_and_b32 s5, s2, 7
    s_lshl_b32 s5, s5, 1
    s_bfe_u32 s6, s2, 0x10003
    s_add_u32 s5, s5, s6
    s_lshr_b32 s6, s2, 4
    s_lshl_b32 s47, s6, 8
    s_add_u32 s47, s47, s5
    s_mul_i32 s7, s47, 514
    s_mul_i32 s48, s3, 16448
    s_add_u32 s58, s7, s48
    v_mul_u32_u24 v22, 8224, v2
    v_lshl_add_u32 v22, v1, 6, v22
    s_waitcnt lgkmcnt(0)
    s_barrier
    ds_read_b128 v[28:31], v3 offset:35072
    ds_read_b128 v[32:35], v3 offset:36096
    ds_read_b128 v[52:55], v3 offset:37120
    ds_read_b128 v[56:59], v3 offset:38144
    s_cmp_lg_u32 s3, 2
    s_cbranch_scc1 L_nowf0
    v_mul_u32_u24 v25, 8224, v0
    s_mov_b64 exec, 0xffff
    buffer_load_ushort v136, v25, s[20:23], s7 offen offset:512
    buffer_load_ushort v137, v25, s[24:27], s7 offen offset:512
    s_mov_b64 exec, -1
    s_lshl_b32 s47, s6, 18
    s_lshl_b32 s7, s5, 14
    s_add_u32 s7, s7, s47
    s_add_u32 s7, s7, 2099328
L_nowf0:
    s_add_u32 s8, s8, 3072
    s_addc_u32 s9, s9, 0
    s_mov_b32 s10, L_B2-L_A-3072
    buffer_load_dword v127, v204, s[8:11], 0 offen
    v_cmp_lt_u32 vcc, 7, v1
    v_cvt_f32_u32 v26, s3
    v_mov_b32 v27, 0x80008000
    v_cndmask_b32 v100, 0, 7, vcc
    v_mul_f32 v26, 0x3b800000, v26
    v_xor_b32 v100, v100, v1
    v_cndmask_b32 v27, 0, v27, vcc
    v_cvt_f32_u32 v100, v100
    v_add_f32 v101, 0x3b000000, v26
    v_mul_f32 v100, s49, v100
    v_mov_b32 v105, v27
    v_mov_b32 v104, v100
    s_cmp_lg_u32 s3, 0
    s_cbranch_scc1 L_cs2a
    v_mov_b32 v26, 0xbef00000
    v_cndmask_b32 v26, 0, v26, vcc
    v_mov_b32 v104, v125
    v_mov_b32 v105, 0
L_cs2a:
    s_lshl_b32 s47, s3, 5
    s_add_u32 s47, s47, 17536
    s_mul_i32 s48, s3, 2080
    s_add_u32 s48, s48, 17536
    s_sub_u32 s44, 16, s3
    s_cmp_eq_u32 s3, 0
    s_cselect_b32 s44, 8, s44
    s_sub_u32 s45, 15, s3
    s_mul_i32 s41, s3, 2064
    s_lshl_b32 s42, s3, 10
    s_mov_b32 s67, 0x69960000
    v_add_f32 v25, v104, v26
    v_add_f32 v103, v100, v101
    v_and_b32 v149, 7, v1
    v_mul_f32 v24, v25, v126
    v_mul_f32 v102, v103, v126
    v_lshlrev_b32 v148, 8, v2
    v_add_f32 v109, v24, v25
    v_add_f32 v117, v102, v103
    v_fma_f32 v110, v25, 2.0, v24
    v_fma_f32 v111, v25, 2.0, v109
    v_fma_f32 v118, v103, 2.0, v102
    v_fma_f32 v119, v103, 2.0, v117
    v_sin_f32 v113, v109
    v_sin_f32 v114, v110
    v_sin_f32 v115, v111
    v_sin_f32 v121, v117
    v_sin_f32 v122, v118
    v_sin_f32 v123, v119
    v_sin_f32 v112, v24
    v_cos_f32 v108, v24
    v_cos_f32 v109, v109
    v_cos_f32 v110, v110
    v_cos_f32 v111, v111
    v_sin_f32 v120, v102
    v_cos_f32 v116, v102
    v_cos_f32 v117, v117
    v_cos_f32 v118, v118
    v_cos_f32 v119, v119
    v_mul_u32_u24 v149, 2064, v149
    v_mov_b32 v150, s3
    v_mov_b32 v7, s44
    v_mov_b32 v8, s45
    v_lshrrev_b32 v200, v2, s67
    v_cvt_pk_bf16_f32 v40, -v112, v108
    v_cvt_pk_bf16_f32 v41, -v113, v109
    v_cvt_pk_bf16_f32 v42, -v114, v110
    v_cvt_pk_bf16_f32 v43, -v115, v111
    v_cvt_pk_bf16_f32 v48, -v120, v116
    v_cvt_pk_bf16_f32 v49, -v121, v117
    v_cvt_pk_bf16_f32 v50, -v122, v118
    v_cvt_pk_bf16_f32 v51, -v123, v119
    v_lshl_add_u32 v4, v1, 3, v148
    v_mul_u32_u24 v5, 1040, v1
    v_add_u32 v149, v149, v148
    v_cndmask_b32 v7, v150, v7, vcc
    v_cndmask_b32 v8, v150, v8, vcc
    v_lshrrev_b32 v202, v1, s67
    v_and_b32 v200, 0x10000, v200
    v_lshl_add_u32 v10, v2, 4, s42
    v_cvt_pk_bf16_f32 v36, v108, v112
    v_xor_b32 v40, v105, v40
    v_cvt_pk_bf16_f32 v37, v109, v113
    v_xor_b32 v41, v105, v41
    v_cvt_pk_bf16_f32 v38, v110, v114
    v_xor_b32 v42, v105, v42
    v_cvt_pk_bf16_f32 v39, v111, v115
    v_xor_b32 v43, v105, v43
    v_cvt_pk_bf16_f32 v44, v116, v120
    v_xor_b32 v48, v27, v48
    v_cvt_pk_bf16_f32 v45, v117, v121
    v_xor_b32 v49, v27, v49
    v_cvt_pk_bf16_f32 v46, v118, v122
    v_xor_b32 v50, v27, v50
    v_cvt_pk_bf16_f32 v47, v119, v123
    v_xor_b32 v51, v27, v51
    v_add_u32 v4, s46, v4
    v_add3_u32 v5, v5, v148, s47
    v_add_u32 v6, s48, v3
    v_lshl_add_u32 v7, v7, 4, v149
    v_lshl_add_u32 v8, v8, 4, v149
    v_add_u32 v9, s41, v3
    v_and_b32 v202, 0x10000, v202
    v_xor_b32 v201, 0x10000, v200
    v_lshl_add_u32 v10, v1, 6, v10
    s_lshl_b32 s41, s2, 14
    s_add_u32 s42, s41, 8192
    s_lshl_b32 s43, s2, 14
    s_add_u32 s43, s43, 2097152
    s_cmp_lg_u32 s3, 0
    s_cbranch_scc1 L_cs2b
    v_mov_b32 v24, 0x0c0c0100
    v_mov_b32 v25, 0x01000c0c
    v_cndmask_b32 v24, v24, v25, vcc
    v_cmp_eq_u32 vcc, 0, v1
    v_mov_b32 v25, 0x3f80
    v_mov_b32 v26, 0xbf80
    v_perm_b32 v36, v36, v36, v24
    v_perm_b32 v37, v37, v37, v24
    v_perm_b32 v38, v38, v38, v24
    v_perm_b32 v39, v39, v39, v24
    v_perm_b32 v40, v40, v40, v24
    v_perm_b32 v41, v41, v41, v24
    v_perm_b32 v42, v42, v42, v24
    v_perm_b32 v43, v43, v43, v24
    v_cndmask_b32 v40, v40, v25, vcc
    v_cndmask_b32 v41, v41, v26, vcc
    v_cndmask_b32 v42, v42, v25, vcc
    v_cndmask_b32 v43, v43, v26, vcc
L_cs2b:
    s_mov_b64 exec, 0x1ff01ff
    buffer_load_ushort v144, v22, s[20:23], s58 offen
    buffer_load_ushort v145, v22, s[24:27], s58 offen
    s_mov_b64 exec, -1
    s_cmp_lg_u32 s3, 2
    s_waitcnt vmcnt(5)
    s_cbranch_scc0 L_xw
    s_waitcnt vmcnt(3)
L_xw:
    s_setprio 1
    ds_read_b64_tr_b16 v[100:101], v4 offset:0
    ds_read_b64_tr_b16 v[102:103], v4 offset:128
    ds_read_b64_tr_b16 v[104:105], v4 offset:1024
    ds_read_b64_tr_b16 v[106:107], v4 offset:1152
    s_waitcnt lgkmcnt(2)
    v_mfma_f32_16x16x32_bf16 v[108:111], v[100:103], v[28:31], 0
    v_mfma_f32_16x16x32_bf16 v[112:115], v[100:103], v[32:35], 0
    s_waitcnt lgkmcnt(0)
    v_mfma_f32_16x16x32_bf16 v[116:119], v[104:107], v[28:31], 0
    v_mfma_f32_16x16x32_bf16 v[120:123], v[104:107], v[32:35], 0
    s_nop 4
    v_cvt_pk_bf16_f32 v100, v108, v112
    v_cvt_pk_bf16_f32 v101, v109, v113
    v_cvt_pk_bf16_f32 v102, v110, v114
    v_cvt_pk_bf16_f32 v103, v111, v115
    ds_write_b128 v5, v[100:103] offset:0
    v_cvt_pk_bf16_f32 v104, v116, v120
    v_cvt_pk_bf16_f32 v105, v117, v121
    v_cvt_pk_bf16_f32 v106, v118, v122
    v_cvt_pk_bf16_f32 v107, v119, v123
    ds_write_b128 v5, v[104:107] offset:16
    s_waitcnt lgkmcnt(0)
    s_barrier
    ds_read_b128 v[100:103], v6 offset:0
    ds_read_b128 v[104:107], v6 offset:1040
    s_waitcnt lgkmcnt(1)
    v_mfma_f32_16x16x32_bf16 v[108:111], v[100:103], v[36:39], 0
    v_mfma_f32_16x16x32_bf16 v[112:115], v[100:103], v[40:43], 0
    s_waitcnt lgkmcnt(0)
    v_mfma_f32_16x16x32_bf16 v[116:119], v[104:107], v[44:47], 0
    v_mfma_f32_16x16x32_bf16 v[120:123], v[104:107], v[48:51], 0
    s_nop 4
    v_cvt_pk_bf16_f32 v100, v108, v112
    v_cvt_pk_bf16_f32 v101, v109, v113
    v_cvt_pk_bf16_f32 v102, v110, v114
    v_cvt_pk_bf16_f32 v103, v111, v115
    ds_write_b128 v7, v[100:103] offset:0
    v_cvt_pk_bf16_f32 v104, v116, v120
    v_cvt_pk_bf16_f32 v105, v117, v121
    v_cvt_pk_bf16_f32 v106, v118, v122
    v_cvt_pk_bf16_f32 v107, v119, v123
    ds_write_b128 v8, v[104:107] offset:1024
    s_mov_b32 s47, 0xfffefffe
    s_cmp_lg_u32 s3, 0
    s_waitcnt lgkmcnt(0)
    s_barrier
    ds_read_b128 v[104:107], v9 offset:1024
    ds_read_b128 v[100:103], v9 offset:0
    s_waitcnt lgkmcnt(1)
    v_mfma_f32_16x16x32_bf16 v[116:119], v[104:107], v[52:55], 0
    v_mfma_f32_16x16x32_bf16 v[120:123], v[104:107], v[56:59], 0
    s_cbranch_scc1 L_nomask
    s_mov_b32 exec_lo, 0x00010001
    s_mov_b32 exec_hi, 0x00010001
    s_waitcnt lgkmcnt(0)
    v_and_b32 v100, 0xffff, v100
    v_and_b32 v101, 0xffff, v101
    v_and_b32 v102, 0xffff, v102
    v_and_b32 v103, 0xffff, v103
    s_mov_b64 exec, -1
L_nomask:
    s_waitcnt lgkmcnt(0)
    v_mfma_f32_16x16x32_bf16 v[108:111], v[100:103], v[52:55], 0
    v_mfma_f32_16x16x32_bf16 v[112:115], v[100:103], v[56:59], 0
    s_nop 3
    v_cvt_pk_bf16_f32 v104, v116, v120
    v_cvt_pk_bf16_f32 v105, v117, v121
    v_cvt_pk_bf16_f32 v106, v118, v122
    v_cvt_pk_bf16_f32 v107, v119, v123
    v_bfi_b32 v104, s47, v104, v200
    v_bfi_b32 v105, s47, v105, v201
    v_bfi_b32 v106, s47, v106, v201
    v_bfi_b32 v107, s47, v107, v200
    buffer_store_dwordx4 v[104:107], v10, s[32:35], s42 offen sc1
    v_cvt_pk_bf16_f32 v100, v108, v112
    v_cvt_pk_bf16_f32 v101, v109, v113
    v_cvt_pk_bf16_f32 v102, v110, v114
    v_cvt_pk_bf16_f32 v103, v111, v115
    v_bfi_b32 v100, s47, v100, v200
    v_bfi_b32 v101, s47, v101, v201
    v_bfi_b32 v102, s47, v102, v201
    v_bfi_b32 v103, s47, v103, v200
    buffer_store_dwordx4 v[100:103], v10, s[32:35], s41 offen sc1
    s_setprio 0
    s_cmp_lg_u32 s3, 1
    s_cbranch_scc1 L_noext1
    ds_read_b128 v[128:131], v148 offset:0
    v_lshlrev_b32 v25, 2, v0
    s_waitcnt lgkmcnt(0)
    v_lshrrev_b32 v128, 16, v128
    v_lshrrev_b32 v129, 16, v129
    v_lshrrev_b32 v130, 16, v130
    v_lshrrev_b32 v131, 16, v131
    s_nop 1
    v_mfma_f32_16x16x32_bf16 v[60:63], v[128:131], v[52:55], 0
    v_mfma_f32_16x16x32_bf16 v[64:67], v[128:131], v[56:59], 0
    s_nop 7
    v_cvt_pk_bf16_f32 v128, v60, v64
    v_bfi_b32 v128, s47, v128, v202
    s_mov_b32 exec_hi, 0
    buffer_store_dword v128, v25, s[32:35], s43 offen offset:2048 sc1
    s_mov_b64 exec, -1
L_noext1:
    s_cmp_lg_u32 s3, 2
    s_cbranch_scc1 L_nowf
    v_lshlrev_b32 v25, 3, v0
    s_waitcnt vmcnt(5)
    v_lshl_or_b32 v136, v137, 16, v136
    v_xor_b32 v137, 0xa5c35a3d, v136
    s_mov_b64 exec, 0xffff
    buffer_store_dwordx2 v[136:137], v25, s[32:35], s7 offen sc1
    s_mov_b64 exec, -1
L_nowf:
    s_lshl_b32 s47, s3, 5
    s_add_u32 s47, s47, s5
    v_lshl_add_u32 v22, v2, 9, s47
    v_mul_u32_u24 v22, 514, v22
    s_lshl_b32 s48, s6, 6
    v_lshl_add_u32 v22, v1, 2, v22
    s_add_u32 s58, s48, 0
    s_add_u32 s59, s48, 8224
    s_add_u32 s60, s48, 131584
    s_add_u32 s61, s48, 139808
    buffer_load_dword v85, v22, s[20:23], s58 offen
    buffer_load_dword v89, v22, s[24:27], s58 offen
    buffer_load_dword v87, v22, s[20:23], s60 offen
    buffer_load_dword v91, v22, s[24:27], s60 offen
    buffer_load_dword v93, v22, s[20:23], s59 offen
    buffer_load_dword v97, v22, s[24:27], s59 offen
    buffer_load_dword v95, v22, s[20:23], s61 offen
    buffer_load_dword v99, v22, s[24:27], s61 offen
    s_mov_b32 s50, 0
    s_mov_b32 s51, 131072
    s_mov_b32 s52, 262144
    s_mov_b32 s53, 393216
    s_mov_b32 s54, 8192
    s_mov_b32 s55, 139264
    s_mov_b32 s56, 270336
    s_mov_b32 s57, 401408
    s_lshl_b32 s37, s6, 4
    s_add_u32 s37, s37, s5
    s_lshl_b32 s37, s37, 6
    s_lshl_b32 s38, s3, 10
    s_mov_b32 s66, 0x10001
    s_lshr_b32 s47, s3, 1
    s_lshl_b32 s47, s47, 8
    s_and_b32 s36, s3, 1
    s_lshl_b32 s36, s36, 3
    s_add_u32 s36, s36, s47
    v_cvt_f32_u32 v26, s3
    v_lshrrev_b32 v28, 1, v1
    v_lshl_add_u32 v149, v2, 5, s3
    v_mul_f32 v26, 0x3c000000, v26
    v_cvt_f32_u32 v28, v28
    v_lshlrev_b32 v149, 14, v149
    v_fma_f32 v24, v126, s49, v26
    v_add_f32 v153, v125, v26
    v_mul_f32 v28, s49, v28
    v_mul_f32 v24, v24, v124
    v_mul_f32 v152, v153, v126
    v_mul_f32 v36, v28, v126
    v_add_f32 v109, v24, v125
    v_add_f32 v117, v152, v153
    v_fma_f32 v37, v28, 2.0, v36
    v_fma_f32 v110, v125, 2.0, v24
    v_fma_f32 v111, v125, 2.0, v109
    v_fma_f32 v118, v153, 2.0, v152
    v_fma_f32 v119, v153, 2.0, v117
    v_sin_f32 v38, v36
    v_sin_f32 v39, v37
    v_cos_f32 v36, v36
    v_cos_f32 v37, v37
    v_sin_f32 v113, v109
    v_sin_f32 v114, v110
    v_sin_f32 v115, v111
    v_sin_f32 v121, v117
    v_sin_f32 v122, v118
    v_sin_f32 v123, v119
    v_and_b32 v29, 1, v1
    v_lshlrev_b32 v14, 12, v2
    v_sin_f32 v112, v24
    v_cos_f32 v108, v24
    v_cos_f32 v109, v109
    v_cos_f32 v110, v110
    v_cos_f32 v111, v111
    v_sin_f32 v120, v152
    v_cos_f32 v116, v152
    v_cos_f32 v117, v117
    v_cos_f32 v118, v118
    v_cos_f32 v119, v119
    v_lshl_add_u32 v17, v1, 2, v148
    v_lshl_add_u32 v149, v1, 2, v149
    v_cmp_eq_u32 vcc, 0, v29
    v_cvt_pk_bf16_f32 v40, v36, v38
    v_cvt_pk_bf16_f32 v42, -v38, v36
    v_cvt_pk_bf16_f32 v41, v37, v39
    v_cvt_pk_bf16_f32 v43, -v39, v37
    v_lshl_add_u32 v14, v1, 4, v14
    v_add_u32 v17, s38, v17
    v_add_u32 v12, s37, v149
    v_cvt_pk_bf16_f32 v60, v108, v112
    v_cvt_pk_bf16_f32 v64, -v112, v108
    v_cvt_pk_bf16_f32 v61, v109, v113
    v_cvt_pk_bf16_f32 v65, -v113, v109
    v_cvt_pk_bf16_f32 v62, v110, v114
    v_cvt_pk_bf16_f32 v66, -v114, v110
    v_cvt_pk_bf16_f32 v63, v111, v115
    v_cvt_pk_bf16_f32 v67, -v115, v111
    v_cvt_pk_bf16_f32 v76, v116, -v120
    v_cvt_pk_bf16_f32 v80, v120, v116
    v_cvt_pk_bf16_f32 v77, v117, -v121
    v_cvt_pk_bf16_f32 v81, v121, v117
    v_cvt_pk_bf16_f32 v78, v118, -v122
    v_cvt_pk_bf16_f32 v82, v122, v118
    v_cvt_pk_bf16_f32 v79, v119, -v123
    v_cvt_pk_bf16_f32 v83, v123, v119
    v_cndmask_b32 v68, 0, v40, vcc
    v_cndmask_b32 v72, 0, v42, vcc
    v_cndmask_b32 v69, v40, 0, vcc
    v_cndmask_b32 v73, v42, 0, vcc
    v_cndmask_b32 v70, 0, v41, vcc
    v_cndmask_b32 v74, 0, v43, vcc
    v_cndmask_b32 v71, v41, 0, vcc
    v_cndmask_b32 v75, v43, 0, vcc
    v_add_u32 v14, s36, v14
    v_add_u32 v15, s46, v3
    s_waitcnt vmcnt(7)
    v_lshlrev_b32 v84, 16, v85
    v_and_b32 v85, 0xffff0000, v85
    s_waitcnt vmcnt(5)
    v_lshlrev_b32 v86, 16, v87
    v_and_b32 v87, 0xffff0000, v87
    v_lshlrev_b32 v88, 16, v89
    v_and_b32 v89, 0xffff0000, v89
    s_waitcnt vmcnt(4)
    v_lshlrev_b32 v90, 16, v91
    v_and_b32 v91, 0xffff0000, v91
    s_waitcnt vmcnt(3)
    v_lshlrev_b32 v92, 16, v93
    v_and_b32 v93, 0xffff0000, v93
    s_waitcnt vmcnt(1)
    v_lshlrev_b32 v94, 16, v95
    v_and_b32 v95, 0xffff0000, v95
    v_lshlrev_b32 v96, 16, v97
    v_and_b32 v97, 0xffff0000, v97
    s_waitcnt vmcnt(0)
    v_lshlrev_b32 v98, 16, v99
    v_and_b32 v99, 0xffff0000, v99
    s_mov_b32 s46, 0
    s_cmp_lg_u32 s2, 0
    s_cbranch_scc1 L_nostar
    v_add_u32 v149, 2099200, v149
    s_lshl_b32 s47, s3, 18
    s_add_u32 s47, s47, 2099328
    v_lshrrev_b32 v24, 3, v0
    v_and_b32 v25, 7, v0
    v_lshlrev_b32 v152, 14, v24
    v_lshl_add_u32 v152, v25, 4, v152
    v_add_u32 v152, s47, v152
    s_mul_i32 s47, s3, 1088
    v_mul_u32_u24 v153, 136, v25
    v_lshl_add_u32 v153, v24, 2, v153
    s_add_u32 s47, s47, 41216
    v_add_u32 v153, s47, v153
    s_mul_i32 s47, s3, 136
    v_mul_u32_u24 v154, 2176, v2
    v_lshl_add_u32 v154, v1, 2, v154
    v_add_u32 v154, s47, v154
    s_mov_b32 s40, 0xa5c35a3d
    s_mov_b32 s64, 2
L_nostar:
    s_waitcnt vmcnt(0)
    s_setprio 1
L_poll1:
    buffer_load_dword v100, v12, s[32:35], s50 offen sc1
    buffer_load_dword v101, v12, s[32:35], s51 offen sc1
    buffer_load_dword v102, v12, s[32:35], s52 offen sc1
    buffer_load_dword v103, v12, s[32:35], s53 offen sc1
    buffer_load_dword v104, v12, s[32:35], s54 offen sc1
    buffer_load_dword v105, v12, s[32:35], s55 offen sc1
    buffer_load_dword v106, v12, s[32:35], s56 offen sc1
    buffer_load_dword v107, v12, s[32:35], s57 offen sc1
L_p1y:
    s_waitcnt vmcnt(0)
L_p1x:
    v_mfma_f32_16x16x32_bf16 v[108:111], v[60:63], v[100:103], 0
    v_mfma_f32_16x16x32_bf16 v[112:115], v[64:67], v[100:103], 0
    v_mfma_f32_16x16x32_bf16 v[116:119], v[60:63], v[104:107], 0
    v_mfma_f32_16x16x32_bf16 v[120:123], v[64:67], v[104:107], 0
    v_bitop3_b32 v24, v100, v101, v202 bitop3:0x7e
    v_bitop3_b32 v25, v102, v103, v202 bitop3:0x7e
    v_bitop3_b32 v26, v104, v105, v202 bitop3:0x7e
    v_bitop3_b32 v27, v106, v107, v202 bitop3:0x7e
    v_or3_b32 v24, v24, v25, v26
    v_bitop3_b32 v24, v24, v27, s66 bitop3:0xa8
    v_cmp_ne_u32 vcc, 0, v24
    v_cvt_pk_bf16_f32 v100, v108, v112
    v_cvt_pk_bf16_f32 v102, v109, v113
    v_cvt_pk_bf16_f32 v104, v110, v114
    v_cvt_pk_bf16_f32 v106, v111, v115
    v_cvt_pk_bf16_f32 v101, v116, v120
    ds_write_b64 v14, v[100:101] offset:17536
    v_cvt_pk_bf16_f32 v103, v117, v121
    ds_write_b64 v14, v[102:103] offset:18560
    v_cvt_pk_bf16_f32 v105, v118, v122
    ds_write_b64 v14, v[104:105] offset:19584
    v_cvt_pk_bf16_f32 v107, v119, v123
    ds_write_b64 v14, v[106:107] offset:20608
    s_cbranch_vccz L_ok1
L_retry1:
    s_sleep 4
    s_add_u32 s46, s46, 1
    s_cmp_lt_u32 s46, 1048576
    s_cbranch_scc1 L_poll1
L_ok1:
    s_cmp_lg_u32 s64, 2
    s_cbranch_scc1 L_p2
    buffer_load_dword v128, v149, s[32:35], s50 offen sc1
    buffer_load_dword v129, v149, s[32:35], s51 offen sc1
    buffer_load_dword v130, v149, s[32:35], s52 offen sc1
    buffer_load_dword v131, v149, s[32:35], s53 offen sc1
    buffer_load_dwordx4 v[136:139], v152, s[32:35], s50 offen sc1
    buffer_load_dwordx4 v[140:143], v152, s[32:35], s51 offen sc1
L_p2:
    s_waitcnt lgkmcnt(0)
    s_barrier
    ds_read_b128 v[100:103], v15 offset:17536
    ds_read_b128 v[104:107], v15 offset:18560
    s_waitcnt lgkmcnt(1)
    v_mfma_f32_16x16x32_bf16 v[108:111], v[68:71], v[100:103], 0
    v_mfma_f32_16x16x32_bf16 v[112:115], v[72:75], v[100:103], 0
    s_waitcnt lgkmcnt(0)
    v_mfma_f32_16x16x32_bf16 v[116:119], v[68:71], v[104:107], 0
    v_mfma_f32_16x16x32_bf16 v[120:123], v[72:75], v[104:107], 0
    s_nop 4
    v_mul_f32 v168, v112, v88
    v_mul_f32 v169, v112, v84
    v_mul_f32 v170, v113, v89
    v_mul_f32 v171, v113, v85
    v_mul_f32 v172, v114, v90
    v_mul_f32 v173, v114, v86
    v_mul_f32 v174, v115, v91
    v_mul_f32 v175, v115, v87
    v_fma_f32 v168, v108, v84, -v168
    v_fmac_f32 v169, v108, v88
    v_fma_f32 v170, v109, v85, -v170
    v_fmac_f32 v171, v109, v89
    v_fma_f32 v172, v110, v86, -v172
    v_fmac_f32 v173, v110, v90
    v_fma_f32 v174, v111, v87, -v174
    v_fmac_f32 v175, v111, v91
    v_cvt_pk_bf16_f32 v100, v169, v168
    v_cvt_pk_bf16_f32 v101, v171, v170
    v_cvt_pk_bf16_f32 v102, v173, v172
    v_cvt_pk_bf16_f32 v103, v175, v174
    s_nop 1
    v_mfma_f32_16x16x32_bf16 v[108:111], v[68:71], v[100:103], 0
    v_mfma_f32_16x16x32_bf16 v[112:115], v[72:75], v[100:103], 0
    v_mul_f32 v176, v120, v96
    v_mul_f32 v177, v120, v92
    v_mul_f32 v178, v121, v97
    v_mul_f32 v179, v121, v93
    v_mul_f32 v180, v122, v98
    v_mul_f32 v181, v122, v94
    v_mul_f32 v182, v123, v99
    v_mul_f32 v183, v123, v95
    v_fma_f32 v176, v116, v92, -v176
    v_fmac_f32 v177, v116, v96
    v_fma_f32 v178, v117, v93, -v178
    v_fmac_f32 v179, v117, v97
    v_fma_f32 v180, v118, v94, -v180
    v_fmac_f32 v181, v118, v98
    v_fma_f32 v182, v119, v95, -v182
    v_fmac_f32 v183, v119, v99
    v_cvt_pk_bf16_f32 v104, v177, v176
    v_cvt_pk_bf16_f32 v105, v179, v178
    v_cvt_pk_bf16_f32 v106, v181, v180
    v_cvt_pk_bf16_f32 v107, v183, v182
    s_nop 1
    v_mfma_f32_16x16x32_bf16 v[116:119], v[68:71], v[104:107], 0
    v_mfma_f32_16x16x32_bf16 v[120:123], v[72:75], v[104:107], 0
    v_cvt_pk_bf16_f32 v100, v112, v108
    v_cvt_pk_bf16_f32 v102, v113, v109
    v_cvt_pk_bf16_f32 v104, v114, v110
    v_cvt_pk_bf16_f32 v106, v115, v111
    s_nop 3
    v_cvt_pk_bf16_f32 v101, v120, v116
    ds_write_b64 v14, v[100:101] offset:0
    v_cvt_pk_bf16_f32 v103, v121, v117
    ds_write_b64 v14, v[102:103] offset:1024
    v_cvt_pk_bf16_f32 v105, v122, v118
    ds_write_b64 v14, v[104:105] offset:2048
    v_cvt_pk_bf16_f32 v107, v123, v119
    ds_write_b64 v14, v[106:107] offset:3072
    s_waitcnt lgkmcnt(0)
    s_barrier
    ds_read_b128 v[100:103], v15 offset:0
    ds_read_b128 v[104:107], v15 offset:1024
    s_waitcnt lgkmcnt(1)
    v_mfma_f32_16x16x32_bf16 v[108:111], v[76:79], v[100:103], 0
    v_mfma_f32_16x16x32_bf16 v[112:115], v[80:83], v[100:103], 0
    s_waitcnt lgkmcnt(0)
    v_mfma_f32_16x16x32_bf16 v[116:119], v[76:79], v[104:107], 0
    v_mfma_f32_16x16x32_bf16 v[120:123], v[80:83], v[104:107], 0
    s_nop 4
    v_cvt_pk_bf16_f32 v100, v108, v112
    v_cvt_pk_bf16_f32 v101, v109, v113
    v_cvt_pk_bf16_f32 v102, v110, v114
    v_cvt_pk_bf16_f32 v103, v111, v115
    v_or_b32 v100, 1, v100
    buffer_store_dword v100, v12, s[32:35], s50 offen sc1
    v_or_b32 v101, 1, v101
    buffer_store_dword v101, v12, s[32:35], s51 offen sc1
    v_or_b32 v102, 1, v102
    buffer_store_dword v102, v12, s[32:35], s52 offen sc1
    v_or_b32 v103, 1, v103
    buffer_store_dword v103, v12, s[32:35], s53 offen sc1
    v_cvt_pk_bf16_f32 v104, v116, v120
    v_cvt_pk_bf16_f32 v105, v117, v121
    v_cvt_pk_bf16_f32 v106, v118, v122
    v_cvt_pk_bf16_f32 v107, v119, v123
    v_or_b32 v104, 1, v104
    buffer_store_dword v104, v12, s[32:35], s54 offen sc1
    v_or_b32 v105, 1, v105
    buffer_store_dword v105, v12, s[32:35], s55 offen sc1
    v_or_b32 v106, 1, v106
    buffer_store_dword v106, v12, s[32:35], s56 offen sc1
    v_or_b32 v107, 1, v107
    buffer_store_dword v107, v12, s[32:35], s57 offen sc1
    s_cmp_eq_u32 s64, 2
    s_cbranch_scc1 L_hook2
    s_setprio 0
L_p3c:
    v_cmp_lt_u32 vcc, 1, v2
    s_cmp_eq_u32 s3, 0
    s_cselect_b32 s48, 0x3d000000, s49
    s_mul_i32 s37, s3, 2192
    s_add_u32 s37, s37, 17536
    v_cvt_f32_u32 v26, s3
    v_and_b32 v183, 1, v2
    v_cvt_f32_u32 v176, s2
    v_mul_f32 v26, 0x3b800000, v26
    v_cvt_f32_u32 v179, v183
    v_mul_f32 v193, 0.5, v125
    v_add_f32 v180, 0x3b000000, v26
    v_sub_f32 v181, s48, v26
    v_mul_f32 v179, 0x3e800000, v179
    v_sub_f32 v182, s49, v180
    v_cndmask_b32 v181, v26, v181, vcc
    v_mul_f32 v176, 0x3a000000, v176
    v_cndmask_b32 v182, v180, v182, vcc
    v_add_f32 v25, v179, v181
    v_mul_f32 v185, v193, v126
    v_add_f32 v24, v179, v182
    v_add_f32 v178, v125, v176
    v_mul_f32 v25, v25, v124
    v_mul_f32 v24, v24, v124
    v_add_f32 v186, v185, v193
    v_mul_f32 v177, v178, v126
    v_add_f32 v109, v24, v125
    v_add_f32 v117, v25, v125
    v_add_f32 v187, v186, v193
    v_sin_f32 v189, v185
    v_cos_f32 v185, v185
    v_add_f32 v169, v177, v178
    v_fma_f32 v110, v125, 2.0, v24
    v_fma_f32 v111, v125, 2.0, v109
    v_fma_f32 v118, v125, 2.0, v25
    v_fma_f32 v119, v125, 2.0, v117
    v_add_f32 v188, v187, v193
    v_sin_f32 v191, v187
    v_lshrrev_b32 v197, 2, v1
    v_cos_f32 v187, v187
    v_fma_f32 v170, v178, 2.0, v177
    v_fma_f32 v171, v178, 2.0, v169
    v_sin_f32 v113, v109
    v_sin_f32 v114, v110
    v_sin_f32 v115, v111
    v_sin_f32 v121, v117
    v_sin_f32 v122, v118
    v_sin_f32 v123, v119
    v_sin_f32 v190, v186
    v_sin_f32 v192, v188
    v_lshlrev_b32 v194, 31, v1
    v_mul_f32 v185, 0x36000000, v185
    v_mul_f32 v189, 0x36000000, v189
    v_mul_u32_u24 v197, 272, v197
    v_and_b32 v198, 3, v1
    v_sin_f32 v112, v24
    v_cos_f32 v108, v24
    v_cos_f32 v109, v109
    v_cos_f32 v110, v110
    v_cos_f32 v111, v111
    v_sin_f32 v120, v25
    v_cos_f32 v116, v25
    v_cos_f32 v117, v117
    v_cos_f32 v118, v118
    v_cos_f32 v119, v119
    v_cos_f32 v186, v186
    v_cos_f32 v188, v188
    v_sin_f32 v173, v169
    v_sin_f32 v174, v170
    v_sin_f32 v175, v171
    v_mov_b32 v184, 0x80008000
    v_xor_b32 v195, 0x36003600, v194
    v_mul_f32 v187, 0x36000000, v187
    v_mul_f32 v191, 0x36000000, v191
    v_cmp_eq_u32 s[38:39], 0, v2
    v_cvt_pk_bf16_f32 v28, v185, -v189
    v_mul_u32_u24 v18, 272, v2
    v_mul_u32_u24 v196, 8768, v183
    v_lshl_add_u32 v197, v198, 2, v197
    v_mov_b32 v199, s3
    v_mov_b32 v19, s44
    v_mov_b32 v20, s45
    v_sin_f32 v172, v177
    v_cos_f32 v168, v177
    v_cos_f32 v169, v169
    v_cos_f32 v170, v170
    v_cos_f32 v171, v171
    v_cndmask_b32 v184, 0, v184, vcc
    v_cvt_pk_bf16_f32 v48, v112, v108
    v_cvt_pk_bf16_f32 v49, v113, v109
    v_cvt_pk_bf16_f32 v50, v114, v110
    v_cvt_pk_bf16_f32 v51, v115, v111
    v_cvt_pk_bf16_f32 v40, v120, v116
    v_cvt_pk_bf16_f32 v41, v121, v117
    v_cvt_pk_bf16_f32 v42, v122, v118
    v_cvt_pk_bf16_f32 v43, v123, v119
    v_mul_f32 v186, 0x36000000, v186
    v_mul_f32 v188, 0x36000000, v188
    v_mul_f32 v190, 0x36000000, v190
    v_mul_f32 v192, 0x36000000, v192
    v_cvt_pk_bf16_f32 v30, v187, -v191
    v_cndmask_b32 v28, v28, v195, s[38:39]
    v_lshl_add_u32 v18, v1, 4, v18
    v_add_u32 v196, v196, v197
    v_cndmask_b32 v19, v199, v19, vcc
    v_cndmask_b32 v20, v199, v20, vcc
    v_lshlrev_b32 v21, 3, v2
    v_cvt_pk_bf16_f32 v52, v168, -v172
    v_cvt_pk_bf16_f32 v56, v172, v168
    v_cvt_pk_bf16_f32 v53, v169, -v173
    v_cvt_pk_bf16_f32 v57, v173, v169
    v_cvt_pk_bf16_f32 v54, v170, -v174
    v_cvt_pk_bf16_f32 v58, v174, v170
    v_cvt_pk_bf16_f32 v55, v171, -v175
    v_cvt_pk_bf16_f32 v59, v175, v171
    v_cvt_pk_bf16_f32 v44, v108, -v112
    v_xor_b32 v48, v184, v48
    v_cvt_pk_bf16_f32 v45, v109, -v113
    v_xor_b32 v49, v184, v49
    v_cvt_pk_bf16_f32 v46, v110, -v114
    v_xor_b32 v50, v184, v50
    v_cvt_pk_bf16_f32 v47, v111, -v115
    v_xor_b32 v51, v184, v51
    v_cvt_pk_bf16_f32 v36, v116, -v120
    v_xor_b32 v40, v184, v40
    v_cvt_pk_bf16_f32 v37, v117, -v121
    v_xor_b32 v41, v184, v41
    v_cvt_pk_bf16_f32 v38, v118, -v122
    v_xor_b32 v42, v184, v42
    v_cvt_pk_bf16_f32 v39, v119, -v123
    v_xor_b32 v43, v184, v43
    v_cvt_pk_bf16_f32 v29, v186, -v190
    v_cvt_pk_bf16_f32 v33, -v186, v190
    v_cvt_pk_bf16_f32 v31, v188, -v192
    v_cvt_pk_bf16_f32 v35, -v188, v192
    v_mov_b32 v34, v30
    v_mov_b32 v32, v28
    v_add_u32 v18, s37, v18
    v_lshl_add_u32 v19, v19, 4, v196
    v_lshl_add_u32 v20, v20, 4, v196
    v_lshl_add_u32 v21, v1, 5, v21
    s_cmp_lg_u32 s3, 0
    s_cbranch_scc1 L_cis2
    v_cndmask_b32 v40, 0, v36, vcc
    v_cndmask_b32 v36, v36, 0, vcc
    v_cndmask_b32 v41, 0, v37, vcc
    v_cndmask_b32 v37, v37, 0, vcc
    v_cndmask_b32 v42, 0, v38, vcc
    v_cndmask_b32 v38, v38, 0, vcc
    v_cndmask_b32 v43, 0, v39, vcc
    v_cndmask_b32 v39, v39, 0, vcc
    v_xor_b32 v25, 0x3f003f00, v194
    v_lshlrev_b32 v4, 4, v2
    v_cndmask_b32 v36, v36, v25, s[38:39]
L_cis2:
    s_cmp_eq_u32 s64, 2
    s_cbranch_scc1 L_noext2
    s_waitcnt vmcnt(0)
    s_setprio 1
L_poll2:
    s_sleep 4
    buffer_load_dword v100, v17, s[32:35], s41 offen offset:0 sc1
    buffer_load_dword v101, v17, s[32:35], s41 offen offset:64 sc1
    buffer_load_dword v102, v17, s[32:35], s41 offen offset:128 sc1
    buffer_load_dword v103, v17, s[32:35], s41 offen offset:192 sc1
    buffer_load_dword v104, v17, s[32:35], s42 offen offset:0 sc1
    buffer_load_dword v105, v17, s[32:35], s42 offen offset:64 sc1
    buffer_load_dword v106, v17, s[32:35], s42 offen offset:128 sc1
    buffer_load_dword v107, v17, s[32:35], s42 offen offset:192 sc1
L_poll2e:
    s_cmp_lg_u32 s3, 0
    s_cbranch_scc1 L_noext2
    buffer_load_dwordx4 v[128:131], v4, s[32:35], s43 offen offset:2048 sc1
L_noext2:
    s_waitcnt vmcnt(0)
    v_mfma_f32_16x16x32_bf16 v[108:111], v[52:55], v[100:103], 0
    v_mfma_f32_16x16x32_bf16 v[112:115], v[56:59], v[100:103], 0
    v_mfma_f32_16x16x32_bf16 v[116:119], v[52:55], v[104:107], 0
    v_mfma_f32_16x16x32_bf16 v[120:123], v[56:59], v[104:107], 0
    v_bitop3_b32 v24, v100, v101, v102 bitop3:0x80
    v_bitop3_b32 v25, v103, v104, v105 bitop3:0x80
    v_bitop3_b32 v24, v24, v106, v107 bitop3:0x80
    v_bitop3_b32 v24, v24, v25, 1 bitop3:0x80
    v_cmp_eq_u32 vcc, 0, v24
    s_cbranch_vccz L_ok2
    s_add_u32 s46, s46, 1
    s_cmp_lt_u32 s46, 1048576
    s_cbranch_scc1 L_poll2
L_ok2:
    s_cmp_lg_u32 s3, 0
    s_cbranch_scc1 L_noext2b
    v_bitop3_b32 v24, v128, v129, v130 bitop3:0x80
    v_bitop3_b32 v24, v24, v131, 1 bitop3:0x80
    v_cmp_eq_u32 vcc, 0, v24
    s_cbranch_vccz L_noext2b
    buffer_load_dwordx4 v[128:131], v4, s[32:35], s43 offen offset:2048 sc1
L_noext2b:
    v_cvt_pk_bf16_f32 v100, v108, v112
    v_cvt_pk_bf16_f32 v101, v109, v113
    v_cvt_pk_bf16_f32 v102, v110, v114
    v_cvt_pk_bf16_f32 v103, v111, v115
    ds_write_b128 v18, v[100:103] offset:0
    v_cvt_pk_bf16_f32 v104, v116, v120
    v_cvt_pk_bf16_f32 v105, v117, v121
    v_cvt_pk_bf16_f32 v106, v118, v122
    v_cvt_pk_bf16_f32 v107, v119, v123
    ds_write_b128 v18, v[104:107] offset:1088
    s_waitcnt lgkmcnt(0)
    s_barrier
    ds_read_b32 v104, v20 offset:18624
    ds_read_b32 v105, v20 offset:20816
    ds_read_b32 v106, v20 offset:23008
    ds_read_b32 v107, v20 offset:25200
    ds_read_b32 v100, v19 offset:17536
    ds_read_b32 v101, v19 offset:19728
    ds_read_b32 v102, v19 offset:21920
    ds_read_b32 v103, v19 offset:24112
    s_waitcnt lgkmcnt(4)
    v_mfma_f32_16x16x32_bf16 v[116:119], v[104:107], v[44:47], 0
    v_mfma_f32_16x16x32_bf16 v[120:123], v[104:107], v[48:51], 0
    s_cbranch_scc1 L_noext3
L_poll3:
    s_waitcnt vmcnt(0)
    v_mfma_f32_16x16x32_bf16 v[108:111], v[128:131], v[52:55], 0
    v_bitop3_b32 v24, v128, v129, v130 bitop3:0x80
    v_bitop3_b32 v24, v24, v131, 1 bitop3:0x80
    v_cmp_eq_u32 vcc, 0, v24
    s_cbranch_vccz L_ok3
    buffer_load_dwordx4 v[128:131], v4, s[32:35], s43 offen offset:2048 sc1
    s_add_u32 s46, s46, 1
    s_cmp_lt_u32 s46, 1048576
    s_cbranch_scc1 L_poll3
L_ok3:
    s_nop 4
    v_cvt_pk_bf16_f32 v24, v108, v108
    s_mov_b32 s47, 0xffff
    s_mov_b64 exec, 0xffff
    s_waitcnt lgkmcnt(3)
    v_bfi_b32 v100, s47, v100, v24
    s_mov_b64 exec, -1
L_noext3:
    s_waitcnt lgkmcnt(0)
    v_mfma_f32_16x16x32_bf16 v[108:111], v[100:103], v[36:39], 0
    v_mfma_f32_16x16x32_bf16 v[112:115], v[100:103], v[40:43], 0
    s_nop 3
    v_cvt_pk_bf16_f32 v61, v116, v120
    v_cvt_pk_bf16_f32 v63, v117, v121
    v_cvt_pk_bf16_f32 v65, v118, v122
    v_cvt_pk_bf16_f32 v67, v119, v123
    v_cvt_pk_bf16_f32 v60, v108, v112
    ds_write_b64 v14, v[60:61] offset:0
    v_cvt_pk_bf16_f32 v62, v109, v113
    ds_write_b64 v14, v[62:63] offset:1024
    v_cvt_pk_bf16_f32 v64, v110, v114
    ds_write_b64 v14, v[64:65] offset:2048
    v_cvt_pk_bf16_f32 v66, v111, v115
    ds_write_b64 v14, v[66:67] offset:3072
    s_waitcnt lgkmcnt(0)
    s_barrier
    ds_read_b128 v[100:103], v15 offset:0
    ds_read_b128 v[104:107], v15 offset:1024
    s_waitcnt lgkmcnt(1)
    v_mfma_f32_16x16x32_bf16 v[108:111], v[100:103], v[28:31], 0
    v_mfma_f32_16x16x32_bf16 v[112:115], v[100:103], v[32:35], 0
    s_waitcnt lgkmcnt(0)
    v_mfma_f32_16x16x32_bf16 v[116:119], v[104:107], v[28:31], 0
    v_mfma_f32_16x16x32_bf16 v[120:123], v[104:107], v[32:35], 0
    s_nop 3
    v_cvt_pk_bf16_f32 v100, v108, v109
    v_cvt_pk_bf16_f32 v101, v110, v111
    buffer_store_dwordx2 v[100:101], v21, s[28:31], s62 offen offset:0
    v_cvt_pk_bf16_f32 v102, v112, v113
    v_cvt_pk_bf16_f32 v103, v114, v115
    buffer_store_dwordx2 v[102:103], v21, s[28:31], s62 offen offset:512
    v_cvt_pk_bf16_f32 v104, v116, v117
    v_cvt_pk_bf16_f32 v105, v118, v119
    buffer_store_dwordx2 v[104:105], v21, s[28:31], s63 offen offset:0
    v_cvt_pk_bf16_f32 v106, v120, v121
    v_cvt_pk_bf16_f32 v107, v122, v123
    buffer_store_dwordx2 v[106:107], v21, s[28:31], s63 offen offset:512
    s_cmp_lg_u32 s3, 2
    s_cbranch_scc1 L_noinv
    v_lshlrev_b32 v24, 2, v0
    v_mov_b32 v25, 0
    s_mov_b32 exec_hi, 0
    buffer_store_dword v25, v24, s[32:35], s7 offen
L_noinv:
L_exit:
    s_endpgm
L_w2:
    s_barrier
L_second:
    ds_read_b128 v[100:103], v15 offset:51200
    ds_read_b128 v[104:107], v15 offset:52224
    ds_read_b32 v85, v154 offset:41216
    ds_read_b32 v87, v154 offset:42304
    ds_read_b32 v89, v154 offset:41284
    ds_read_b32 v91, v154 offset:42372
    s_waitcnt lgkmcnt(5)
    v_mfma_f32_16x16x32_bf16 v[108:111], v[68:71], v[100:103], 0
    v_mfma_f32_16x16x32_bf16 v[112:115], v[72:75], v[100:103], 0
    s_waitcnt lgkmcnt(4)
    v_mfma_f32_16x16x32_bf16 v[116:119], v[68:71], v[104:107], 0
    v_mfma_f32_16x16x32_bf16 v[120:123], v[72:75], v[104:107], 0
    s_waitcnt lgkmcnt(3)
    v_lshlrev_b32 v84, 16, v85
    v_and_b32 v85, 0xffff0000, v85
    s_waitcnt lgkmcnt(2)
    v_lshlrev_b32 v86, 16, v87
    v_and_b32 v87, 0xffff0000, v87
    s_waitcnt lgkmcnt(1)
    v_lshlrev_b32 v88, 16, v89
    v_and_b32 v89, 0xffff0000, v89
    s_waitcnt lgkmcnt(0)
    v_lshlrev_b32 v90, 16, v91
    v_and_b32 v91, 0xffff0000, v91
    v_mul_f32 v168, v112, v85
    v_mul_f32 v169, v112, v84
    v_mul_f32 v170, v114, v87
    v_mul_f32 v171, v114, v86
    v_mul_f32 v172, v120, v89
    v_mul_f32 v173, v120, v88
    v_mul_f32 v174, v122, v91
    v_mul_f32 v175, v122, v90
    v_fma_f32 v168, v108, v84, -v168
    v_fmac_f32 v169, v108, v85
    v_fma_f32 v170, v110, v86, -v170
    v_fmac_f32 v171, v110, v87
    v_fma_f32 v172, v116, v88, -v172
    v_fmac_f32 v173, v116, v89
    v_fma_f32 v174, v118, v90, -v174
    v_fmac_f32 v175, v118, v91
    v_cvt_pk_bf16_f32 v100, v169, v168
    v_cvt_pk_bf16_f32 v102, v171, v170
    v_cvt_pk_bf16_f32 v104, v173, v172
    v_cvt_pk_bf16_f32 v106, v175, v174
    v_mfma_f32_16x16x32_bf16 v[108:111], v[68:71], v[100:103], 0
    v_mfma_f32_16x16x32_bf16 v[112:115], v[72:75], v[100:103], 0
    v_mfma_f32_16x16x32_bf16 v[116:119], v[68:71], v[104:107], 0
    v_mfma_f32_16x16x32_bf16 v[120:123], v[72:75], v[104:107], 0
    s_nop 5
    v_cvt_pk_bf16_f32 v168, v112, v108
    s_nop 0
    v_cvt_pk_bf16_f32 v169, v120, v116
    ds_write_b64 v14, v[168:169] offset:17536
    v_cvt_pk_bf16_f32 v170, v114, v110
    v_cvt_pk_bf16_f32 v171, v122, v118
    ds_write_b64 v14, v[170:171] offset:19584
    s_waitcnt lgkmcnt(0)
    s_barrier
    ds_read_b128 v[172:175], v15 offset:17536
    s_waitcnt lgkmcnt(0)
    v_mfma_f32_16x16x32_bf16 v[108:111], v[76:79], v[172:175], 0
    v_mfma_f32_16x16x32_bf16 v[112:115], v[80:83], v[172:175], 0
    s_nop 7
    v_cvt_pk_bf16_f32 v168, v108, v112
    v_cvt_pk_bf16_f32 v169, v109, v113
    v_cvt_pk_bf16_f32 v170, v110, v114
    v_cvt_pk_bf16_f32 v171, v111, v115
    v_or_b32 v168, 1, v168
    buffer_store_dword v168, v149, s[32:35], s50 offen sc1
    v_or_b32 v169, 1, v169
    buffer_store_dword v169, v149, s[32:35], s51 offen sc1
    v_or_b32 v170, 1, v170
    buffer_store_dword v170, v149, s[32:35], s52 offen sc1
    v_or_b32 v171, 1, v171
    buffer_store_dword v171, v149, s[32:35], s53 offen sc1
    s_barrier
    buffer_load_dword v100, v17, s[32:35], s41 offen offset:0 sc1
    buffer_load_dword v101, v17, s[32:35], s41 offen offset:64 sc1
    buffer_load_dword v102, v17, s[32:35], s41 offen offset:128 sc1
    buffer_load_dword v103, v17, s[32:35], s41 offen offset:192 sc1
    buffer_load_dword v104, v17, s[32:35], s42 offen offset:0 sc1
    buffer_load_dword v105, v17, s[32:35], s42 offen offset:64 sc1
    buffer_load_dword v106, v17, s[32:35], s42 offen offset:128 sc1
    buffer_load_dword v107, v17, s[32:35], s42 offen offset:192 sc1
    s_branch L_p3c
L_hook2:
    v_mov_b32 v169, 0
    s_waitcnt vmcnt(8)
L_pollx:
    v_mfma_f32_16x16x32_bf16 v[108:111], v[60:63], v[128:131], 0
    v_mfma_f32_16x16x32_bf16 v[112:115], v[64:67], v[128:131], 0
    v_bitop3_b32 v24, v128, v129, v202 bitop3:0x7e
    v_bitop3_b32 v25, v130, v131, v202 bitop3:0x7e
    v_bitop3_b32 v25, v24, v25, s66 bitop3:0xa8
    v_bitop3_b32 v172, v136, v137, s40 bitop3:0x96
    v_bitop3_b32 v173, v138, v139, s40 bitop3:0x96
    v_bitop3_b32 v174, v140, v141, s40 bitop3:0x96
    v_bitop3_b32 v175, v142, v143, s40 bitop3:0x96
    ds_write2_b32 v153, v136, v138 offset0:0 offset1:17
    ds_write2_b32 v153, v140, v142 offset0:8 offset1:25
    v_or3_b32 v25, v25, v172, v173
    v_or3_b32 v25, v25, v174, v175
    v_cmp_ne_u32 vcc, 0, v25
    v_cvt_pk_bf16_f32 v168, v108, v112
    ds_write_b64 v14, v[168:169] offset:51200
    v_cvt_pk_bf16_f32 v168, v109, v113
    ds_write_b64 v14, v[168:169] offset:52224
    v_cvt_pk_bf16_f32 v168, v110, v114
    ds_write_b64 v14, v[168:169] offset:53248
    v_cvt_pk_bf16_f32 v168, v111, v115
    ds_write_b64 v14, v[168:169] offset:54272
    s_waitcnt lgkmcnt(0)
    s_cbranch_vccz L_w2
L_retryx:
    s_sleep 2
    buffer_load_dword v128, v149, s[32:35], s50 offen sc1
    buffer_load_dword v129, v149, s[32:35], s51 offen sc1
    buffer_load_dword v130, v149, s[32:35], s52 offen sc1
    buffer_load_dword v131, v149, s[32:35], s53 offen sc1
    buffer_load_dwordx4 v[136:139], v152, s[32:35], s50 offen sc1
    buffer_load_dwordx4 v[140:143], v152, s[32:35], s51 offen sc1
    s_waitcnt vmcnt(0)
    s_add_u32 s46, s46, 1
    s_cmp_lt_u32 s46, 1048576
    s_cbranch_scc1 L_pollx
    s_branch L_w2
L_B2:
    s_lshl_b32 s45, s45, 17
    s_lshl_b32 s44, s5, 7
    s_add_u32 s63, s44, s45
    v_lshrrev_b32 v17, 2, v0
    v_and_b32 v15, 1, v0
    v_lshl_add_u32 v17, v17, 10, s63
    v_lshl_add_u32 v17, v15, 6, v17
    s_mov_b32 s38, 2097152
    s_mov_b32 s39, 0x20000
    s_mov_b32 s36, s16
    s_mov_b32 s37, s17
    s_barrier
    global_load_dword v13, v17, s[16:17]
    s_lshr_b32 s52, s3, 1
    s_mul_i32 s44, s3, 4352
    v_and_b32 v1, 63, v0
    s_lshl_b32 s47, s46, 1
    v_and_b32 v11, 256, v0
    v_add_lshl_u32 v11, v11, v0, 11
    s_add_u32 s6, s47, 524288
    s_add_u32 s7, s47, 1048576
    s_mov_b32 m0, s44
L_kg0:
    s_add_u32 s8, s8, 3072
    s_addc_u32 s9, s9, 0
    s_mov_b32 s10, L_end-L_B2-3072
    buffer_load_dword v14, v204, s[8:11], 0 offen
    s_and_b32 s53, s3, 1
    s_mul_i32 s48, s52, 4624
    s_lshl_b32 s49, s53, 8
    v_bfe_u32 v3, v0, 4, 2
    s_add_u32 s48, s48, s49
    v_and_b32 v2, 15, v0
    s_add_u32 s48, s48, 72560
    s_mul_i32 s49, s52, 5376
    v_lshrrev_b32 v133, 1, v3
    s_add_u32 s49, s49, 34816
    s_mul_i32 s66, s53, 1088
    v_and_b32 v134, 1, v3
    v_lshlrev_b32 v21, 9, v133
    s_add_u32 s66, s66, s49
    s_mul_i32 s50, s3, 3200
    v_lshl_add_u32 v21, v134, 4, v21
    v_sub_u32 v134, 4, v133
    s_add_u32 s50, s50, 91152
    v_mul_u32_u24 v133, 120, v133
    v_lshl_add_u32 v24, v3, 8, s50
    v_lshlrev_b32 v134, v134, v2
    s_mul_i32 s51, s52, 6400
    v_mul_u32_u24 v31, 1344, v3
    v_add_u32 v22, v24, v134
    s_add_u32 s51, s51, 91136
    s_lshl_b32 s67, s53, 9
    v_add_u32 v23, v22, v133
    v_lshrrev_b32 v133, 2, v2
    v_and_b32 v134, 3, v2
    s_add_u32 s67, s51, s67
    v_mul_u32_u24 v28, 1344, v133
    s_add_u32 s67, s67, 1024
    v_lshl_add_u32 v133, v134, 1, v133
    s_lshl_b32 s69, s52, 9
    v_lshl_add_u32 v31, v2, 2, v31
    s_add_u32 s69, s69, 56320
    v_sub_u32 v133, 5, v133
    s_mul_i32 s62, s52, 384
    v_lshl_add_u32 v132, v1, 2, s48
    v_mov_b32 v39, 0
    s_add_u32 s62, s62, 133120
    v_lshlrev_b32 v136, 2, v1
    v_med3_i32 v133, v133, 0, 2
    v_add_u32 v31, s66, v31
    v_lshl_add_u32 v30, v3, 2, s50
    v_sub_u32 v135, 63, v1
    v_lshl_add_u32 v130, v2, 2, s62
    ds_write_b32 v132, v39
    v_mul_u32_u24 v20, 272, v2
    v_lshl_add_u32 v25, v1, 3, s67
    v_cmp_eq_u32 s[54:55], 0, v1
    v_add_u32 v136, 134656, v136
    v_lshlrev_b32 v133, 3, v133
    ds_write_b32 v132, v39 offset:16
    v_subrev_u32 v30, 16, v30
    ds_write_b32 v31, v39
    v_lshl_add_u32 v29, v135, 3, s49
    v_lshl_add_u32 v19, v135, 2, s69
    v_lshl_add_u32 v131, v135, 2, s62
    ds_write_b32 v130, v39 offset:256
    v_lshl_add_u32 v20, v3, 4, v20
    v_lshl_add_u32 v21, v2, 5, v21
    v_add_u32 v128, 3200, v25
    v_cndmask_b32 v135, 0, 4, s[54:55]
    v_lshrrev_b32 v32, 9, v11
    v_lshl_add_u32 v28, v134, 2, v28
    v_lshlrev_b32 v139, v133, -1
    ds_write_b32 v136, v39
    ds_write_b32 v30, v39
    s_mov_b32 s60, 0x05040100
    ds_write_b32 v19, v39
    v_add_u32 v20, s44, v20
    s_mov_b32 s61, 0x07060302
    v_add_u32 v21, s50, v21
    v_lshl_add_u32 v24, v2, 2, v24
    v_lshl_add_u32 v26, v1, 4, s51
    v_sub_u32 v27, v25, v135
    v_sub_u32 v129, v128, v135
    v_add_u32 v32, 73088, v32
    v_add_u32 v28, s49, v28
    v_lshlrev_b32 v139, v133, v139
    ds_write_b32 v19, v39 offset:256
    s_sub_u32 s44, 7, s3
    s_min_u32 s44, s44, 4
    s_mov_b32 s40, 0x0fe01ff0
    s_mov_b32 s41, 0x380007c0
    s_lshl_b32 s42, s44, 4
    s_lshr_b64 s[40:41], s[40:41], s42
    s_and_b32 s40, s40, 0xffff
    s_cmp_eq_u32 s44, 4
    s_cselect_b32 s40, 0x07f0, s40
    s_movk_i32 s41, 0x3f80
    s_cselect_b32 s41, 0xffff, s41
    s_lshl_b32 s44, s44, 10
    s_add_u32 s44, s44, 61440
    v_lshlrev_b32 v134, 3, v3
    v_lshlrev_b32 v132, v2, s40
    v_bfe_u32 v132, v132, v134, 8
    v_lshl_add_u32 v134, v1, 4, s44
    v_lshl_or_b32 v132, v132, 15, v132
    v_lshrrev_b32 v228, 0, v132
    v_lshrrev_b32 v229, 2, v132
    v_lshrrev_b32 v230, 4, v132
    v_lshrrev_b32 v231, 6, v132
    v_and_b32 v228, 0x10001, v228
    v_and_b32 v229, 0x10001, v229
    v_and_b32 v230, 0x10001, v230
    v_and_b32 v231, 0x10001, v231
    v_mul_u32_u24 v228, s41, v228
    v_mul_u32_u24 v229, s41, v229
    v_mul_u32_u24 v230, s41, v230
    v_mul_u32_u24 v231, s41, v231
    ds_write_b128 v134, v[228:231]
    s_cmp_ge_u32 s3, 4
    s_cbranch_scc1 L_Badr1
    s_mul_i32 s44, s3, 4624
    s_add_u32 s44, s44, 72544
    v_lshlrev_b32 v134, 5, v2
    v_lshl_add_u32 v33, v3, 4, v134
    v_add_u32 v33, s44, v33
    s_lshl_b32 s44, s3, 12
    s_add_u32 s44, s44, 116736
    v_lshl_add_u32 v35, v3, 3, v134
    v_add_u32 v35, s44, v35
    s_mul_i32 s44, s3, 5376
    s_add_u32 s44, s44, 38872
    v_and_b32 v132, 3, v2
    v_lshrrev_b32 v134, 2, v2
    v_mul_u32_u24 v34, 1344, v132
    v_lshl_add_u32 v34, v134, 3, v34
    v_sub_u32 v34, s44, v34
    v_lshl_add_u32 v34, v3, 4, v34
    s_mul_i32 s44, s3, 384
    s_add_u32 s44, s44, 133180
    v_lshlrev_b32 v132, 2, v2
    v_sub_u32 v36, s44, v132
    v_lshl_add_u32 v36, v3, 4, v36
    s_lshl_b32 s44, s3, 2
    s_add_u32 s44, s44, 134656
    v_mov_b32 v37, s44
    v_mov_b32 v38, 1
    s_mul_i32 s44, s3, 4624
    s_add_u32 s44, s44, 73040
    v_add_u32 v137, v2, v3
    v_lshl_add_u32 v137, v137, 4, s44
    s_lshl_b32 s44, s3, 9
    s_add_u32 s44, s44, 56440
    v_lshlrev_b32 v132, 3, v2
    v_sub_u32 v138, s44, v132
    v_lshl_add_u32 v138, v3, 4, v138
    v_lshlrev_b32 v135, 4, v1
    v_add_u32 v135, 61440, v135
L_Badr1:
    s_waitcnt vmcnt(9)
    v_lshlrev_b32 v10, 16, v10
    s_waitcnt vmcnt(7)
    v_lshlrev_b32 v5, 16, v5
    v_mul_f32 v86, 0x3fb8aa3b, v10
    v_lshlrev_b32 v4, 16, v4
    v_exp_f32 v86, v86
    v_mov_b32 v88, 0x3f80
    s_waitcnt vmcnt(6)
    v_lshlrev_b32 v6, 16, v6
    ds_write_addtid_b32 v88 offset:0
    v_cvt_pk_bf16_f32 v86, v86, v86
    s_waitcnt vmcnt(5)
    v_lshlrev_b32 v7, 16, v7
    v_lshlrev_b32 v10, 16, v86
    s_waitcnt vmcnt(4)
    v_lshlrev_b32 v8, 16, v8
    v_mul_f32 v5, v5, v10
    v_mul_f32 v4, v4, v10
    v_mul_f32 v5, 0.15915494, v5
    v_mul_f32 v4, 0x3fb8aa3b, v4
    v_mul_f32 v99, 0x41000000, v5
    v_mul_f32 v98, 0x41000000, v4
    v_fract_f32 v99, v99
    v_exp_f32 v98, v98
    v_cos_f32 v96, v99
    v_sin_f32 v97, v99
    v_fract_f32 v143, v5
    v_mul_f32 v96, v96, v98
    v_exp_f32 v142, v4
    v_mul_f32 v97, v97, v98
    v_cos_f32 v140, v143
    v_pk_mul_f32 v[100:101], v[96:97], v[96:97] op_sel:[1,1] op_sel_hi:[1,0]
    v_cvt_pk_bf16_f32 v89, v96, v97
    v_pk_fma_f32 v[100:101], v[96:97], v[96:97], v[100:101] op_sel:[0,0,0] op_sel_hi:[0,1,1] neg_lo:[0,0,1]
    s_waitcnt vmcnt(2)
    v_lshlrev_b32 v16, 16, v16
    ds_write_addtid_b32 v89 offset:272
    v_pk_mul_f32 v[104:105], v[100:101], v[100:101] op_sel:[1,1] op_sel_hi:[1,0]
    v_pk_mul_f32 v[102:103], v[96:97], v[100:101] op_sel:[1,1] op_sel_hi:[1,0]
    v_pk_fma_f32 v[104:105], v[100:101], v[100:101], v[104:105] op_sel:[0,0,0] op_sel_hi:[0,1,1] neg_lo:[0,0,1]
    v_pk_fma_f32 v[102:103], v[96:97], v[100:101], v[102:103] op_sel:[0,0,0] op_sel_hi:[0,1,1] neg_lo:[0,0,1]
    v_pk_mul_f32 v[106:107], v[96:97], v[104:105] op_sel:[1,1] op_sel_hi:[1,0]
    v_cvt_pk_bf16_f32 v90, v100, v101
    v_pk_mul_f32 v[108:109], v[100:101], v[104:105] op_sel:[1,1] op_sel_hi:[1,0]
    v_cvt_pk_bf16_f32 v91, v102, v103
    v_pk_fma_f32 v[106:107], v[96:97], v[104:105], v[106:107] op_sel:[0,0,0] op_sel_hi:[0,1,1] neg_lo:[0,0,1]
    v_pk_mul_f32 v[110:111], v[102:103], v[104:105] op_sel:[1,1] op_sel_hi:[1,0]
    ds_write_addtid_b32 v90 offset:544
    v_cvt_pk_bf16_f32 v92, v104, v105
    v_pk_fma_f32 v[108:109], v[100:101], v[104:105], v[108:109] op_sel:[0,0,0] op_sel_hi:[0,1,1] neg_lo:[0,0,1]
    v_pk_mul_f32 v[112:113], v[104:105], v[104:105] op_sel:[1,1] op_sel_hi:[1,0]
    ds_write_addtid_b32 v91 offset:816
    v_cvt_pk_bf16_f32 v93, v106, v107
    v_pk_fma_f32 v[110:111], v[102:103], v[104:105], v[110:111] op_sel:[0,0,0] op_sel_hi:[0,1,1] neg_lo:[0,0,1]
    v_pk_mul_f32 v[114:115], v[106:107], v[104:105] op_sel:[1,1] op_sel_hi:[1,0]
    v_sin_f32 v141, v143
    s_cmp_ge_u32 s3, 4
    s_cbranch_scc1 L_ue0
    buffer_load_dwordx2 v[184:185], v11, s[36:39], s47 offen offset:0
L_ue0:
    ds_write_addtid_b32 v92 offset:1088
    v_cvt_pk_bf16_f32 v94, v108, v109
    v_pk_fma_f32 v[112:113], v[104:105], v[104:105], v[112:113] op_sel:[0,0,0] op_sel_hi:[0,1,1] neg_lo:[0,0,1]
    v_pk_mul_f32 v[116:117], v[108:109], v[104:105] op_sel:[1,1] op_sel_hi:[1,0]
    ds_write_addtid_b32 v93 offset:1360
    v_cvt_pk_bf16_f32 v95, v110, v111
    v_pk_fma_f32 v[114:115], v[106:107], v[104:105], v[114:115] op_sel:[0,0,0] op_sel_hi:[0,1,1] neg_lo:[0,0,1]
    v_pk_mul_f32 v[118:119], v[110:111], v[104:105] op_sel:[1,1] op_sel_hi:[1,0]
    ds_write_addtid_b32 v94 offset:1632
    v_cvt_pk_bf16_f32 v88, v112, v113
    v_pk_fma_f32 v[116:117], v[108:109], v[104:105], v[116:117] op_sel:[0,0,0] op_sel_hi:[0,1,1] neg_lo:[0,0,1]
    v_pk_mul_f32 v[120:121], v[112:113], v[104:105] op_sel:[1,1] op_sel_hi:[1,0]
    v_lshlrev_b32 v9, 16, v9
    v_mul_f32 v6, v6, v10
    v_mul_f32 v7, v7, v10
    ds_write_addtid_b32 v95 offset:1904
    v_cvt_pk_bf16_f32 v89, v114, v115
    v_pk_fma_f32 v[118:119], v[110:111], v[104:105], v[118:119] op_sel:[0,0,0] op_sel_hi:[0,1,1] neg_lo:[0,0,1]
    v_pk_mul_f32 v[122:123], v[114:115], v[104:105] op_sel:[1,1] op_sel_hi:[1,0]
    ds_write_addtid_b32 v88 offset:2176
    v_cvt_pk_bf16_f32 v90, v116, v117
    v_pk_fma_f32 v[120:121], v[112:113], v[104:105], v[120:121] op_sel:[0,0,0] op_sel_hi:[0,1,1] neg_lo:[0,0,1]
    v_pk_mul_f32 v[124:125], v[116:117], v[104:105] op_sel:[1,1] op_sel_hi:[1,0]
    v_mul_f32 v140, v140, v142
    v_mul_f32 v141, v141, v142
    ds_write_addtid_b32 v89 offset:2448
    v_cvt_pk_bf16_f32 v91, v118, v119
    v_pk_fma_f32 v[122:123], v[114:115], v[104:105], v[122:123] op_sel:[0,0,0] op_sel_hi:[0,1,1] neg_lo:[0,0,1]
    v_pk_mul_f32 v[126:127], v[118:119], v[104:105] op_sel:[1,1] op_sel_hi:[1,0]
    v_pk_mul_f32 v[148:149], v[6:7], v[8:9] op_sel:[1,1] op_sel_hi:[1,0]
    s_cmp_ge_u32 s3, 4
    s_cbranch_scc1 L_ue1
    buffer_load_dwordx2 v[186:187], v11, s[36:39], s47 offen offset:1024
L_ue1:
    ds_write_addtid_b32 v90 offset:2720
    v_cvt_pk_bf16_f32 v92, v120, v121
    v_pk_fma_f32 v[124:125], v[116:117], v[104:105], v[124:125] op_sel:[0,0,0] op_sel_hi:[0,1,1] neg_lo:[0,0,1]
    v_pk_mul_f32 v[150:151], v[140:141], v[140:141] op_sel:[1,1] op_sel_hi:[1,0]
    ds_write_addtid_b32 v91 offset:2992
    v_cvt_pk_bf16_f32 v93, v122, v123
    v_pk_fma_f32 v[126:127], v[118:119], v[104:105], v[126:127] op_sel:[0,0,0] op_sel_hi:[0,1,1] neg_lo:[0,0,1]
    v_mul_f32 v147, 0x43000000, v5
    v_pk_fma_f32 v[148:149], v[6:7], v[8:9], v[148:149] op_sel:[0,0,0] op_sel_hi:[0,1,1] neg_lo:[0,0,1]
    ds_write_addtid_b32 v92 offset:3264
    v_cvt_pk_bf16_f32 v94, v124, v125
    v_pk_fma_f32 v[150:151], v[140:141], v[140:141], v[150:151] op_sel:[0,0,0] op_sel_hi:[0,1,1] neg_lo:[0,0,1]
    ds_write_addtid_b32 v93 offset:3536
    v_cvt_pk_bf16_f32 v95, v126, v127
    v_mul_f32 v146, 0x43000000, v4
    v_fract_f32 v147, v147
    v_pk_mul_f32 v[152:153], v[148:149], v[140:141] op_sel:[1,1] op_sel_hi:[1,0]
    ds_write_addtid_b32 v94 offset:3808
    v_pk_mul_f32 v[154:155], v[150:151], v[150:151] op_sel:[1,1] op_sel_hi:[1,0]
    ds_write_addtid_b32 v95 offset:4080
    v_exp_f32 v146, v146
    v_cos_f32 v144, v147
    v_sin_f32 v145, v147
    v_pk_fma_f32 v[152:153], v[148:149], v[140:141], v[152:153] op_sel:[0,0,0] op_sel_hi:[0,1,1] neg_lo:[0,0,1]
    ds_read_b128 v[40:43], v20 offset:0
    v_pk_fma_f32 v[154:155], v[150:151], v[150:151], v[154:155] op_sel:[0,0,0] op_sel_hi:[0,1,1] neg_lo:[0,0,1]
    v_pk_mul_f32 v[156:157], v[148:149], v[150:151] op_sel:[1,1] op_sel_hi:[1,0]
    ds_read_b128 v[44:47], v20 offset:64
    v_pk_mul_f32 v[158:159], v[152:153], v[150:151] op_sel:[1,1] op_sel_hi:[1,0]
    ds_read_b128 v[48:51], v20 offset:128
    s_cmp_ge_u32 s3, 4
    s_cbranch_scc1 L_ue2
    buffer_load_dwordx2 v[188:189], v11, s[36:39], s6 offen offset:0
L_ue2:
    v_pk_fma_f32 v[156:157], v[148:149], v[150:151], v[156:157] op_sel:[0,0,0] op_sel_hi:[0,1,1] neg_lo:[0,0,1]
    v_pk_mul_f32 v[160:161], v[148:149], v[154:155] op_sel:[1,1] op_sel_hi:[1,0]
    v_cvt_pk_bf16_f32 v88, v148, -v149
    ds_read_b128 v[52:55], v20 offset:192
    v_pk_fma_f32 v[158:159], v[152:153], v[150:151], v[158:159] op_sel:[0,0,0] op_sel_hi:[0,1,1] neg_lo:[0,0,1]
    v_pk_mul_f32 v[162:163], v[152:153], v[154:155] op_sel:[1,1] op_sel_hi:[1,0]
    v_cvt_pk_bf16_f32 v89, v152, -v153
    v_mul_f32 v144, v144, v146
    v_mul_f32 v145, v145, v146
    v_pk_fma_f32 v[160:161], v[148:149], v[154:155], v[160:161] op_sel:[0,0,0] op_sel_hi:[0,1,1] neg_lo:[0,0,1]
    v_pk_mul_f32 v[164:165], v[156:157], v[154:155] op_sel:[1,1] op_sel_hi:[1,0]
    ds_write_addtid_b32 v88 offset:0
    v_cvt_pk_bf16_f32 v90, v156, -v157
    v_pk_fma_f32 v[162:163], v[152:153], v[154:155], v[162:163] op_sel:[0,0,0] op_sel_hi:[0,1,1] neg_lo:[0,0,1]
    v_pk_mul_f32 v[166:167], v[158:159], v[154:155] op_sel:[1,1] op_sel_hi:[1,0]
    ds_write_addtid_b32 v89 offset:272
    v_cvt_pk_bf16_f32 v91, v158, -v159
    v_pk_fma_f32 v[164:165], v[156:157], v[154:155], v[164:165] op_sel:[0,0,0] op_sel_hi:[0,1,1] neg_lo:[0,0,1]
    ds_write_addtid_b32 v90 offset:544
    v_cvt_pk_bf16_f32 v92, v160, -v161
    v_pk_mul_f32 v[86:87], v[148:149], v[144:145] op_sel:[1,1] op_sel_hi:[1,0]
    v_pk_fma_f32 v[166:167], v[158:159], v[154:155], v[166:167] op_sel:[0,0,0] op_sel_hi:[0,1,1] neg_lo:[0,0,1]
    ds_write_addtid_b32 v91 offset:816
    v_cvt_pk_bf16_f32 v93, v162, -v163
    v_pk_mul_f32 v[98:99], v[152:153], v[144:145] op_sel:[1,1] op_sel_hi:[1,0]
    ds_write_addtid_b32 v92 offset:1088
    v_cvt_pk_bf16_f32 v94, v164, -v165
    v_pk_fma_f32 v[86:87], v[148:149], v[144:145], v[86:87] op_sel:[0,0,0] op_sel_hi:[0,1,1] neg_lo:[0,0,1]
    v_pk_mul_f32 v[96:97], v[156:157], v[144:145] op_sel:[1,1] op_sel_hi:[1,0]
    ds_write_addtid_b32 v93 offset:1360
    s_cmp_ge_u32 s3, 4
    s_cbranch_scc1 L_ue3
    buffer_load_dwordx2 v[190:191], v11, s[36:39], s6 offen offset:1024
L_ue3:
    v_cvt_pk_bf16_f32 v95, v166, -v167
    v_pk_fma_f32 v[98:99], v[152:153], v[144:145], v[98:99] op_sel:[0,0,0] op_sel_hi:[0,1,1] neg_lo:[0,0,1]
    v_pk_mul_f32 v[100:101], v[158:159], v[144:145] op_sel:[1,1] op_sel_hi:[1,0]
    ds_write_addtid_b32 v94 offset:1632
    v_cvt_pk_bf16_f32 v88, v86, -v87
    v_pk_fma_f32 v[96:97], v[156:157], v[144:145], v[96:97] op_sel:[0,0,0] op_sel_hi:[0,1,1] neg_lo:[0,0,1]
    v_pk_mul_f32 v[102:103], v[160:161], v[144:145] op_sel:[1,1] op_sel_hi:[1,0]
    ds_write_addtid_b32 v95 offset:1904
    v_cvt_pk_bf16_f32 v89, v98, -v99
    v_pk_fma_f32 v[100:101], v[158:159], v[144:145], v[100:101] op_sel:[0,0,0] op_sel_hi:[0,1,1] neg_lo:[0,0,1]
    v_pk_mul_f32 v[106:107], v[162:163], v[144:145] op_sel:[1,1] op_sel_hi:[1,0]
    ds_write_addtid_b32 v88 offset:2176
    v_cvt_pk_bf16_f32 v90, v96, -v97
    v_pk_fma_f32 v[102:103], v[160:161], v[144:145], v[102:103] op_sel:[0,0,0] op_sel_hi:[0,1,1] neg_lo:[0,0,1]
    v_pk_mul_f32 v[108:109], v[164:165], v[144:145] op_sel:[1,1] op_sel_hi:[1,0]
    ds_write_addtid_b32 v89 offset:2448
    v_cvt_pk_bf16_f32 v91, v100, -v101
    v_pk_fma_f32 v[106:107], v[162:163], v[144:145], v[106:107] op_sel:[0,0,0] op_sel_hi:[0,1,1] neg_lo:[0,0,1]
    v_pk_mul_f32 v[110:111], v[166:167], v[144:145] op_sel:[1,1] op_sel_hi:[1,0]
    ds_write_addtid_b32 v90 offset:2720
    v_cvt_pk_bf16_f32 v92, v102, -v103
    v_pk_fma_f32 v[108:109], v[164:165], v[144:145], v[108:109] op_sel:[0,0,0] op_sel_hi:[0,1,1] neg_lo:[0,0,1]
    ds_write_addtid_b32 v91 offset:2992
    v_cvt_pk_bf16_f32 v93, v106, -v107
    v_pk_fma_f32 v[110:111], v[166:167], v[144:145], v[110:111] op_sel:[0,0,0] op_sel_hi:[0,1,1] neg_lo:[0,0,1]
    ds_write_addtid_b32 v92 offset:3264
    v_cvt_pk_bf16_f32 v94, v108, -v109
    ds_write_addtid_b32 v93 offset:3536
    v_cvt_pk_bf16_f32 v95, v110, -v111
    ds_write_addtid_b32 v94 offset:3808
    ds_write_addtid_b32 v95 offset:4080
    ds_read_b128 v[56:59], v20 offset:0
    ds_read_b128 v[60:63], v20 offset:64
    v_pk_mul_f32 v[114:115], v[86:87], v[144:145] op_sel:[1,1] op_sel_hi:[1,0]
    ds_read_b128 v[64:67], v20 offset:128
    v_pk_mul_f32 v[116:117], v[96:97], v[144:145] op_sel:[1,1] op_sel_hi:[1,0]
    v_pk_fma_f32 v[114:115], v[86:87], v[144:145], v[114:115] op_sel:[0,0,0] op_sel_hi:[0,1,1] neg_lo:[0,0,1]
    v_pk_mul_f32 v[118:119], v[102:103], v[144:145] op_sel:[1,1] op_sel_hi:[1,0]
    ds_read_b128 v[68:71], v20 offset:192
    v_pk_fma_f32 v[116:117], v[96:97], v[144:145], v[116:117] op_sel:[0,0,0] op_sel_hi:[0,1,1] neg_lo:[0,0,1]
    v_pk_mul_f32 v[104:105], v[108:109], v[144:145] op_sel:[1,1] op_sel_hi:[1,0]
    v_pk_mul_f32 v[112:113], v[144:145], v[144:145] op_sel:[1,1] op_sel_hi:[1,0]
    v_cvt_pk_bf16_f32 v88, v114, -v115
    v_pk_fma_f32 v[118:119], v[102:103], v[144:145], v[118:119] op_sel:[0,0,0] op_sel_hi:[0,1,1] neg_lo:[0,0,1]
    v_pk_mul_f32 v[120:121], v[114:115], v[144:145] op_sel:[1,1] op_sel_hi:[1,0]
    v_cvt_pk_bf16_f32 v89, v116, -v117
    v_pk_fma_f32 v[104:105], v[108:109], v[144:145], v[104:105] op_sel:[0,0,0] op_sel_hi:[0,1,1] neg_lo:[0,0,1]
    v_pk_mul_f32 v[122:123], v[116:117], v[144:145] op_sel:[1,1] op_sel_hi:[1,0]
    v_pk_fma_f32 v[112:113], v[144:145], v[144:145], v[112:113] op_sel:[0,0,0] op_sel_hi:[0,1,1] neg_lo:[0,0,1]
    ds_write_addtid_b32 v88 offset:0
    v_cvt_pk_bf16_f32 v90, v118, -v119
    v_pk_fma_f32 v[120:121], v[114:115], v[144:145], v[120:121] op_sel:[0,0,0] op_sel_hi:[0,1,1] neg_lo:[0,0,1]
    v_pk_mul_f32 v[124:125], v[118:119], v[144:145] op_sel:[1,1] op_sel_hi:[1,0]
    ds_write_addtid_b32 v89 offset:272
    v_cvt_pk_bf16_f32 v91, v104, -v105
    v_pk_fma_f32 v[122:123], v[116:117], v[144:145], v[122:123] op_sel:[0,0,0] op_sel_hi:[0,1,1] neg_lo:[0,0,1]
    v_pk_mul_f32 v[126:127], v[104:105], v[144:145] op_sel:[1,1] op_sel_hi:[1,0]
    ds_write_addtid_b32 v90 offset:544
    v_cvt_pk_bf16_f32 v92, v120, -v121
    v_pk_fma_f32 v[124:125], v[118:119], v[144:145], v[124:125] op_sel:[0,0,0] op_sel_hi:[0,1,1] neg_lo:[0,0,1]
    v_pk_mul_f32 v[146:147], v[114:115], v[112:113] op_sel:[1,1] op_sel_hi:[1,0]
    ds_write_addtid_b32 v91 offset:816
    v_cvt_pk_bf16_f32 v93, v122, -v123
    v_pk_fma_f32 v[126:127], v[104:105], v[144:145], v[126:127] op_sel:[0,0,0] op_sel_hi:[0,1,1] neg_lo:[0,0,1]
    v_pk_mul_f32 v[140:141], v[118:119], v[112:113] op_sel:[1,1] op_sel_hi:[1,0]
    ds_write_addtid_b32 v92 offset:1088
    v_cvt_pk_bf16_f32 v94, v124, -v125
    v_pk_fma_f32 v[146:147], v[114:115], v[112:113], v[146:147] op_sel:[0,0,0] op_sel_hi:[0,1,1] neg_lo:[0,0,1]
    v_pk_mul_f32 v[150:151], v[120:121], v[112:113] op_sel:[1,1] op_sel_hi:[1,0]
    ds_write_addtid_b32 v93 offset:1360
    v_cvt_pk_bf16_f32 v95, v126, -v127
    v_pk_fma_f32 v[140:141], v[118:119], v[112:113], v[140:141] op_sel:[0,0,0] op_sel_hi:[0,1,1] neg_lo:[0,0,1]
    v_pk_mul_f32 v[154:155], v[124:125], v[112:113] op_sel:[1,1] op_sel_hi:[1,0]
    ds_write_addtid_b32 v94 offset:1632
    v_cvt_pk_bf16_f32 v88, v146, -v147
    v_pk_fma_f32 v[150:151], v[120:121], v[112:113], v[150:151] op_sel:[0,0,0] op_sel_hi:[0,1,1] neg_lo:[0,0,1]
    v_pk_mul_f32 v[148:149], v[146:147], v[112:113] op_sel:[1,1] op_sel_hi:[1,0]
    ds_write_addtid_b32 v95 offset:1904
    v_cvt_pk_bf16_f32 v89, v140, -v141
    v_pk_fma_f32 v[154:155], v[124:125], v[112:113], v[154:155] op_sel:[0,0,0] op_sel_hi:[0,1,1] neg_lo:[0,0,1]
    v_pk_mul_f32 v[152:153], v[140:141], v[112:113] op_sel:[1,1] op_sel_hi:[1,0]
    ds_write_addtid_b32 v88 offset:2176
    v_cvt_pk_bf16_f32 v90, v150, -v151
    v_pk_fma_f32 v[148:149], v[146:147], v[112:113], v[148:149] op_sel:[0,0,0] op_sel_hi:[0,1,1] neg_lo:[0,0,1]
    v_pk_mul_f32 v[98:99], v[150:151], v[112:113] op_sel:[1,1] op_sel_hi:[1,0]
    ds_write_addtid_b32 v89 offset:2448
    v_cvt_pk_bf16_f32 v91, v154, -v155
    v_pk_fma_f32 v[152:153], v[140:141], v[112:113], v[152:153] op_sel:[0,0,0] op_sel_hi:[0,1,1] neg_lo:[0,0,1]
    v_pk_mul_f32 v[156:157], v[154:155], v[112:113] op_sel:[1,1] op_sel_hi:[1,0]
    ds_write_addtid_b32 v90 offset:2720
    v_cvt_pk_bf16_f32 v92, v148, -v149
    v_pk_fma_f32 v[98:99], v[150:151], v[112:113], v[98:99] op_sel:[0,0,0] op_sel_hi:[0,1,1] neg_lo:[0,0,1]
    ds_write_addtid_b32 v91 offset:2992
    v_cvt_pk_bf16_f32 v93, v152, -v153
    v_pk_fma_f32 v[156:157], v[154:155], v[112:113], v[156:157] op_sel:[0,0,0] op_sel_hi:[0,1,1] neg_lo:[0,0,1]
    ds_write_addtid_b32 v92 offset:3264
    v_cvt_pk_bf16_f32 v94, v98, -v99
    ds_write_addtid_b32 v93 offset:3536
    v_cvt_pk_bf16_f32 v95, v156, -v157
    ds_write_addtid_b32 v94 offset:3808
    s_waitcnt lgkmcnt(12)
    v_mfma_f32_16x16x32_bf16 v[72:75], v[56:59], v[40:43], 0
    ds_write_addtid_b32 v95 offset:4080
    ds_read_b128 v[56:59], v20 offset:0
    v_mfma_f32_16x16x32_bf16 v[72:75], v[60:63], v[44:47], v[72:75]
    ds_read_b128 v[60:63], v20 offset:64
    v_mfma_f32_16x16x32_bf16 v[72:75], v[64:67], v[48:51], v[72:75]
    ds_read_b128 v[64:67], v20 offset:128
    v_mfma_f32_16x16x32_bf16 v[72:75], v[68:71], v[52:55], v[72:75]
    v_pk_mul_f32 v[142:143], v[112:113], v[112:113] op_sel:[1,1] op_sel_hi:[1,0]
    ds_read_b128 v[68:71], v20 offset:192
    v_pk_fma_f32 v[142:143], v[112:113], v[112:113], v[142:143] op_sel:[0,0,0] op_sel_hi:[0,1,1] neg_lo:[0,0,1]
    v_pk_mul_f32 v[158:159], v[146:147], v[142:143] op_sel:[1,1] op_sel_hi:[1,0]
    v_pk_mul_f32 v[100:101], v[150:151], v[142:143] op_sel:[1,1] op_sel_hi:[1,0]
    v_pk_fma_f32 v[158:159], v[146:147], v[142:143], v[158:159] op_sel:[0,0,0] op_sel_hi:[0,1,1] neg_lo:[0,0,1]
    v_pk_mul_f32 v[160:161], v[148:149], v[142:143] op_sel:[1,1] op_sel_hi:[1,0]
    v_pk_fma_f32 v[100:101], v[150:151], v[142:143], v[100:101] op_sel:[0,0,0] op_sel_hi:[0,1,1] neg_lo:[0,0,1]
    v_pk_mul_f32 v[162:163], v[98:99], v[142:143] op_sel:[1,1] op_sel_hi:[1,0]
    v_cvt_pk_bf16_f32 v88, v158, -v159
    v_pk_fma_f32 v[160:161], v[148:149], v[142:143], v[160:161] op_sel:[0,0,0] op_sel_hi:[0,1,1] neg_lo:[0,0,1]
    v_pk_mul_f32 v[106:107], v[158:159], v[142:143] op_sel:[1,1] op_sel_hi:[1,0]
    v_cvt_pk_bf16_f32 v89, v100, -v101
    v_pk_fma_f32 v[162:163], v[98:99], v[142:143], v[162:163] op_sel:[0,0,0] op_sel_hi:[0,1,1] neg_lo:[0,0,1]
    v_pk_mul_f32 v[164:165], v[100:101], v[142:143] op_sel:[1,1] op_sel_hi:[1,0]
    ds_write_addtid_b32 v88 offset:0
    v_cvt_pk_bf16_f32 v90, v160, -v161
    v_pk_fma_f32 v[106:107], v[158:159], v[142:143], v[106:107] op_sel:[0,0,0] op_sel_hi:[0,1,1] neg_lo:[0,0,1]
    v_pk_mul_f32 v[166:167], v[160:161], v[142:143] op_sel:[1,1] op_sel_hi:[1,0]
    ds_write_addtid_b32 v89 offset:272
    v_cvt_pk_bf16_f32 v91, v162, -v163
    v_pk_fma_f32 v[164:165], v[100:101], v[142:143], v[164:165] op_sel:[0,0,0] op_sel_hi:[0,1,1] neg_lo:[0,0,1]
    v_pk_mul_f32 v[110:111], v[162:163], v[142:143] op_sel:[1,1] op_sel_hi:[1,0]
    ds_write_addtid_b32 v90 offset:544
    v_cvt_pk_bf16_f32 v92, v106, -v107
    v_pk_fma_f32 v[166:167], v[160:161], v[142:143], v[166:167] op_sel:[0,0,0] op_sel_hi:[0,1,1] neg_lo:[0,0,1]
    v_pk_mul_f32 v[86:87], v[106:107], v[142:143] op_sel:[1,1] op_sel_hi:[1,0]
    ds_write_addtid_b32 v91 offset:816
    v_cvt_pk_bf16_f32 v93, v164, -v165
    v_pk_fma_f32 v[110:111], v[162:163], v[142:143], v[110:111] op_sel:[0,0,0] op_sel_hi:[0,1,1] neg_lo:[0,0,1]
    ds_write_addtid_b32 v92 offset:1088
    v_cvt_pk_bf16_f32 v94, v166, -v167
    v_pk_fma_f32 v[86:87], v[106:107], v[142:143], v[86:87] op_sel:[0,0,0] op_sel_hi:[0,1,1] neg_lo:[0,0,1]
    ds_write_addtid_b32 v93 offset:1360
    v_cvt_pk_bf16_f32 v95, v110, -v111
    ds_write_addtid_b32 v94 offset:1632
    v_cvt_pk_bf16_f32 v88, v86, -v87
    ds_write_addtid_b32 v95 offset:1904
    s_waitcnt lgkmcnt(11)
    v_mfma_f32_16x16x32_bf16 v[76:79], v[56:59], v[40:43], 0
    ds_write_addtid_b32 v88 offset:2176
    ds_read_b128 v[56:59], v20 offset:0
    s_waitcnt lgkmcnt(12)
    v_mfma_f32_16x16x32_bf16 v[76:79], v[60:63], v[44:47], v[76:79]
    ds_read_b128 v[60:63], v20 offset:64
    s_waitcnt lgkmcnt(12)
    v_mfma_f32_16x16x32_bf16 v[76:79], v[64:67], v[48:51], v[76:79]
    ds_read_b128 v[64:67], v20 offset:128
    s_waitcnt lgkmcnt(12)
    v_mfma_f32_16x16x32_bf16 v[76:79], v[68:71], v[52:55], v[76:79]
    ds_read_b128 v[68:71], v20 offset:192
    ds_write_b128 v21, v[72:75]
    s_nop 5
    ds_write_b64 v22, v[76:77] offset:1024
    ds_write_b64 v23, v[78:79] offset:1032
    s_waitcnt lgkmcnt(6)
    v_mfma_f32_16x16x32_bf16 v[80:83], v[56:59], v[40:43], 0
    s_waitcnt lgkmcnt(5)
    v_mfma_f32_16x16x32_bf16 v[80:83], v[60:63], v[44:47], v[80:83]
    s_waitcnt lgkmcnt(4)
    v_mfma_f32_16x16x32_bf16 v[80:83], v[64:67], v[48:51], v[80:83]
    s_waitcnt lgkmcnt(3)
    v_mfma_f32_16x16x32_bf16 v[80:83], v[68:71], v[52:55], v[80:83]
    s_nop 7
    ds_write_b32 v24, v80 offset:2048
    ds_write_b32 v24, v81 offset:2112
    ds_write_b32 v24, v82 offset:2176
    ds_write_b32 v24, v83 offset:2240
    v_cndmask_b32 v20, 0, v16, s[54:55]
    s_setprio 0
    s_cmp_ge_u32 s3, 4
    s_cbranch_scc1 L_nl
    v_add_u32 v11, 1048576, v11
    buffer_load_dwordx2 v[208:209], v11, s[36:39], s47 offen offset:0
    buffer_load_dwordx2 v[210:211], v11, s[36:39], s47 offen offset:1024
L_nl:
    s_waitcnt lgkmcnt(0)
    s_barrier
    s_bitcmp1_b32 s3, 0
    s_cbranch_scc1 L_Bc1
    ds_read_b64 v[40:41], v25 offset:16
    ds_read_b64 v[56:57], v25 offset:3216
    ds_read_b32 v42, v25 offset:24
    ds_read_b32 v58, v25 offset:3224
    ds_read_b32 v43, v27 offset:16
    ds_read_b32 v59, v129 offset:16
    ds_read2_b32 v[44:45], v27 offset0:2 offset1:3
    ds_read2_b32 v[60:61], v129 offset0:2 offset1:3
    s_waitcnt lgkmcnt(6)
    v_add_f32 v40, v40, v56
    v_add_f32 v41, v41, v57
    s_waitcnt lgkmcnt(4)
    v_add_f32 v42, v42, v58
    s_waitcnt lgkmcnt(2)
    v_add_f32 v43, v43, v59
    s_waitcnt lgkmcnt(0)
    v_add_f32 v44, v44, v60
    v_add_f32 v45, v45, v61
    v_cvt_pk_bf16_f32 v92, v42, v42
    v_cvt_pk_bf16_f32 v84, v42, v41
    v_cvt_pk_bf16_f32 v85, v40, v40
    ds_write_b64 v29, v[84:85] offset:64
    v_cvt_pk_bf16_f32 v86, v41, v40
    v_cvt_pk_bf16_f32 v87, v40, v43
    ds_write_b64 v29, v[86:87] offset:1408
    v_mov_b32 v88, v85
    v_cvt_pk_bf16_f32 v89, v43, v45
    ds_write_b64 v29, v[88:89] offset:2752
    v_mov_b32 v90, v87
    v_cvt_pk_bf16_f32 v91, v45, v44
    ds_write_b64 v29, v[90:91] offset:4096
    v_readlane_b32 s44, v92, 63
    v_readlane_b32 s45, v84, 63
    v_readlane_b32 s69, v86, 63
    v_and_b32 v93, s44, v139
    s_nop 1
    v_writelane_b32 v93, s45, 11
    v_writelane_b32 v93, s69, 15
    s_mov_b64 exec, 0xffff
    ds_write_b32 v28, v93 offset:48
    s_mov_b64 exec, -1
    s_branch L_Bc2
L_Bc1:
    ds_read_b128 v[52:55], v26 offset:16
    ds_read_b128 v[48:51], v26 offset:0
    ds_read_b128 v[68:71], v26 offset:3216
    ds_read_b128 v[64:67], v26 offset:3200
    ds_read2_b32 v[40:41], v25 offset0:5 offset1:6
    ds_read2_b32 v[56:57], v128 offset0:5 offset1:6
    ds_read2_b32 v[42:43], v25 offset0:133 offset1:134
    ds_read2_b32 v[58:59], v128 offset0:133 offset1:134
    s_waitcnt lgkmcnt(5)
    v_add_f32 v55, v55, v71
    v_add_f32 v54, v54, v70
    v_add_f32 v53, v53, v69
    v_add_f32 v52, v52, v68
    s_waitcnt lgkmcnt(4)
    v_add_f32 v51, v51, v67
    v_add_f32 v50, v50, v66
    v_add_f32 v49, v49, v65
    v_add_f32 v52, v52, v20
    v_cvt_pk_bf16_f32 v84, v55, v54
    v_cvt_pk_bf16_f32 v85, v53, v52
    ds_write_b64 v29, v[84:85] offset:576
    v_cvt_pk_bf16_f32 v86, v54, v53
    v_cvt_pk_bf16_f32 v87, v52, v51
    ds_write_b64 v29, v[86:87] offset:1920
    v_mov_b32 v88, v85
    v_cvt_pk_bf16_f32 v89, v51, v50
    ds_write_b64 v29, v[88:89] offset:3264
    v_mov_b32 v90, v87
    v_cvt_pk_bf16_f32 v91, v50, v49
    ds_write_b64 v29, v[90:91] offset:4608
    s_waitcnt lgkmcnt(6)
    v_add_f32 v40, v40, v56
    v_add_f32 v41, v41, v57
    s_waitcnt lgkmcnt(4)
    v_add_f32 v42, v42, v58
    v_add_f32 v43, v43, v59
    v_cvt_pk_bf16_f32 v92, v41, v41
    v_cvt_pk_bf16_f32 v94, v43, v42
    v_writelane_b32 v41, 0, 63
    ds_write_b32 v131, v94
    v_cvt_pk_bf16_f32 v93, v41, v40
    s_mov_b32 exec_lo, 0
    s_mov_b32 exec_hi, 0x80000000
    ds_write_b32 v131, v92 offset:320
    s_mov_b64 exec, -1
    ds_write_b32 v19, v93 offset:128
L_Bc2:
    s_cmp_ge_u32 s3, 4
    s_cbranch_scc1 L_nous
    s_waitcnt vmcnt(2)
    v_perm_b32 v108, v186, v184, s60
    ds_write_b32 v32, v108 offset:0
    v_perm_b32 v109, v190, v188, s60
    ds_write_b32 v32, v109 offset:1024
    v_perm_b32 v110, v186, v184, s61
    ds_write_b32 v32, v110 offset:4624
    v_perm_b32 v111, v190, v188, s61
    ds_write_b32 v32, v111 offset:5648
    v_perm_b32 v112, v187, v185, s60
    ds_write_b32 v32, v112 offset:9248
    v_perm_b32 v113, v191, v189, s60
    ds_write_b32 v32, v113 offset:10272
    v_perm_b32 v114, v187, v185, s61
    ds_write_b32 v32, v114 offset:13872
    v_perm_b32 v115, v191, v189, s61
    ds_write_b32 v32, v115 offset:14896
L_nous:
    s_waitcnt lgkmcnt(0)
    s_barrier
    s_cbranch_scc0 L_conv
    buffer_load_dwordx2 v[188:189], v11, s[36:39], s6 offen offset:0
    buffer_load_dwordx2 v[190:191], v11, s[36:39], s6 offen offset:1024
    s_branch L_Bfin
L_conv:
    ds_read_b64 v[72:73], v34 offset:1024
    ds_read_b64 v[74:75], v34 offset:1032
    ds_read_b128 v[76:79], v33 offset:512
    ds_read_b64 v[80:81], v34 offset:512
    ds_read_b64 v[82:83], v34 offset:520
    ds_read_b128 v[84:87], v33 offset:1024
    ds_read_b64 v[88:89], v34 offset:960
    ds_read_b64 v[90:91], v34 offset:968
    ds_read_b128 v[92:95], v33 offset:448
    ds_read_b64 v[96:97], v34 offset:448
    s_waitcnt lgkmcnt(5)
    v_mfma_f32_16x16x32_bf16 v[40:43], v[72:75], v[76:79], 0
    ds_read_b64 v[98:99], v34 offset:456
    ds_read_b128 v[100:103], v33 offset:960
    v_mfma_f32_16x16x32_bf16 v[44:47], v[80:83], v[76:79], 0
    ds_read_b64 v[104:105], v34 offset:896
    ds_read_b64 v[106:107], v34 offset:904
    s_waitcnt lgkmcnt(5)
    v_mfma_f32_16x16x32_bf16 v[44:47], v[72:75], v[84:87], v[44:47]
    ds_read_b128 v[108:111], v33 offset:384
    ds_read_b64 v[112:113], v34 offset:384
    v_mfma_f32_16x16x32_bf16 v[48:51], v[80:83], v[84:87], 0
    ds_read_b64 v[114:115], v34 offset:392
    ds_read_b128 v[116:119], v33 offset:896
    v_mfma_f32_16x16x32_bf16 v[40:43], v[88:91], v[92:95], v[40:43]
    ds_read_b64 v[120:121], v34 offset:832
    ds_read_b64 v[122:123], v34 offset:840
    s_waitcnt lgkmcnt(5)
    v_mfma_f32_16x16x32_bf16 v[44:47], v[96:99], v[92:95], v[44:47]
    ds_read_b128 v[124:127], v33 offset:320
    ds_read_b64 v[4:5], v34 offset:320
    v_mfma_f32_16x16x32_bf16 v[44:47], v[88:91], v[100:103], v[44:47]
    ds_read_b64 v[6:7], v34 offset:328
    ds_read_b128 v[8:11], v33 offset:832
    v_mfma_f32_16x16x32_bf16 v[48:51], v[96:99], v[100:103], v[48:51]
    ds_read_b64 v[12:13], v34 offset:768
    ds_read_b64 v[14:15], v34 offset:776
    v_mfma_f32_16x16x32_bf16 v[40:43], v[104:107], v[108:111], v[40:43]
    ds_read_b128 v[16:19], v33 offset:256
    ds_read_b64 v[20:21], v34 offset:256
    s_waitcnt lgkmcnt(5)
    v_mfma_f32_16x16x32_bf16 v[44:47], v[112:115], v[108:111], v[44:47]
    ds_read_b64 v[22:23], v34 offset:264
    ds_read_b128 v[24:27], v33 offset:768
    v_mfma_f32_16x16x32_bf16 v[44:47], v[104:107], v[116:119], v[44:47]
    ds_read_b64 v[28:29], v34 offset:704
    ds_read_b64 v[30:31], v34 offset:712
    v_mfma_f32_16x16x32_bf16 v[48:51], v[112:115], v[116:119], v[48:51]
    ds_read_b128 v[140:143], v33 offset:192
    ds_read_b64 v[144:145], v34 offset:192
    v_mfma_f32_16x16x32_bf16 v[40:43], v[120:123], v[124:127], v[40:43]
    ds_read_b64 v[146:147], v34 offset:200
    ds_read_b128 v[148:151], v33 offset:704
    v_mfma_f32_16x16x32_bf16 v[44:47], v[4:7], v[124:127], v[44:47]
    ds_read_b64 v[152:153], v34 offset:640
    ds_read_b64 v[154:155], v34 offset:648
    s_waitcnt lgkmcnt(5)
    v_mfma_f32_16x16x32_bf16 v[44:47], v[120:123], v[8:11], v[44:47]
    ds_read_b128 v[156:159], v33 offset:128
    ds_read_b64 v[160:161], v34 offset:128
    ds_read_b128 v[240:243], v135 offset:3072
    v_mfma_f32_16x16x32_bf16 v[48:51], v[4:7], v[8:11], v[48:51]
    ds_read_b64 v[162:163], v34 offset:136
    ds_read_b128 v[164:167], v33 offset:640
    ds_read_b128 v[236:239], v135 offset:2048
    v_mfma_f32_16x16x32_bf16 v[40:43], v[12:15], v[16:19], v[40:43]
    ds_read_b64 v[168:169], v34 offset:576
    ds_read_b64 v[170:171], v34 offset:584
    ds_read_b128 v[244:247], v135 offset:4096
    v_mfma_f32_16x16x32_bf16 v[44:47], v[20:23], v[16:19], v[44:47]
    ds_read_b128 v[172:175], v33 offset:64
    ds_read_b64 v[176:177], v34 offset:64
    ds_read_b128 v[232:235], v135 offset:1024
    v_mfma_f32_16x16x32_bf16 v[44:47], v[12:15], v[24:27], v[44:47]
    ds_read_b64 v[178:179], v34 offset:72
    ds_read_b128 v[228:231], v135 offset:0
    v_mfma_f32_16x16x32_bf16 v[48:51], v[20:23], v[24:27], v[48:51]
    ds_read_b128 v[180:183], v33 offset:576
    s_mul_i32 s44, s3, 384
    s_add_u32 s44, s44, 133440
    v_mov_b32 v133, s44
    v_mfma_f32_16x16x32_bf16 v[40:43], v[28:31], v[140:143], v[40:43]
    ds_read_b128 v[184:187], v137 offset:0
    s_waitcnt lgkmcnt(5)
    v_mfma_f32_16x16x32_bf16 v[44:47], v[144:147], v[140:143], v[44:47]
    ds_read_b128 v[188:191], v33 offset:1536
    ds_read_b32 v133, v133
    v_mfma_f32_16x16x32_bf16 v[44:47], v[28:31], v[148:151], v[44:47]
    ds_read_b128 v[220:223], v33 offset:2048
    v_mfma_f32_16x16x32_bf16 v[48:51], v[144:147], v[148:151], v[48:51]
    ds_read_b128 v[224:227], v137 offset:256
    v_mfma_f32_16x16x32_bf16 v[40:43], v[152:155], v[156:159], v[40:43]
    ds_read_b128 v[248:251], v33 offset:1472
    v_mfma_f32_16x16x32_bf16 v[44:47], v[160:163], v[156:159], v[44:47]
    ds_read_b128 v[212:215], v33 offset:1984
    v_mfma_f32_16x16x32_bf16 v[44:47], v[152:155], v[164:167], v[44:47]
    ds_read_b128 v[76:79], v137 offset:512
    v_mfma_f32_16x16x32_bf16 v[48:51], v[160:163], v[164:167], v[48:51]
    ds_read_b128 v[84:87], v33 offset:1408
    v_mfma_f32_16x16x32_bf16 v[40:43], v[168:171], v[172:175], v[40:43]
    ds_read_b128 v[92:95], v33 offset:1920
    s_waitcnt lgkmcnt(5)
    v_mfma_f32_16x16x32_bf16 v[44:47], v[176:179], v[172:175], v[44:47]
    ds_read_b128 v[100:103], v137 offset:768
    v_mfma_f32_16x16x32_bf16 v[44:47], v[168:171], v[180:183], v[44:47]
    ds_read_b128 v[108:111], v33 offset:1344
    v_and_b32 v244, v244, v133
    v_mfma_f32_16x16x32_bf16 v[48:51], v[176:179], v[180:183], v[48:51]
    ds_read_b128 v[116:119], v33 offset:1856
    v_and_b32 v245, v245, v133
    v_mfma_f32_16x16x32_bf16 v[196:199], v[184:187], v[240:243], 0
    ds_read_b128 v[124:127], v33 offset:1280
    v_and_b32 v246, v246, v133
    v_mfma_f32_16x16x32_bf16 v[192:195], v[184:187], v[236:239], 0
    ds_read_b128 v[8:11], v33 offset:1792
    v_and_b32 v247, v247, v133
    v_mfma_f32_16x16x32_bf16 v[48:51], v[72:75], v[188:191], v[48:51]
    ds_read_b128 v[16:19], v33 offset:1216
    v_mfma_f32_16x16x32_bf16 v[52:55], v[80:83], v[188:191], 0
    ds_read_b128 v[140:143], v33 offset:1728
    v_mfma_f32_16x16x32_bf16 v[52:55], v[72:75], v[220:223], v[52:55]
    ds_read_b128 v[148:151], v33 offset:1152
    v_cvt_pk_bf16_f32 v24, v192, v196
    v_mfma_f32_16x16x32_bf16 v[56:59], v[80:83], v[220:223], 0
    ds_read_b128 v[156:159], v33 offset:1664
    v_cvt_pk_bf16_f32 v25, v193, v197
    v_mfma_f32_16x16x32_bf16 v[204:207], v[224:227], v[240:243], 0
    ds_read_b128 v[164:167], v33 offset:1088
    v_cvt_pk_bf16_f32 v26, v194, v198
    v_mfma_f32_16x16x32_bf16 v[200:203], v[224:227], v[236:239], 0
    ds_read_b128 v[172:175], v33 offset:1600
    v_cvt_pk_bf16_f32 v27, v195, v199
    s_waitcnt lgkmcnt(5)
    v_mfma_f32_16x16x32_bf16 v[48:51], v[88:91], v[248:251], v[48:51]
    ds_read_b64 v[180:181], v34 offset:0
    v_cvt_pk_bf16_f32 v252, v40, v41
    v_mfma_f32_16x16x32_bf16 v[52:55], v[96:99], v[248:251], v[52:55]
    ds_read_b64 v[182:183], v34 offset:8
    v_cvt_pk_bf16_f32 v253, v42, v43
    v_mfma_f32_16x16x32_bf16 v[52:55], v[88:91], v[212:215], v[52:55]
    ds_read_b128 v[188:191], v33 offset:512
    ds_write_b64 v35, v[252:253] offset:0
    v_mfma_f32_16x16x32_bf16 v[56:59], v[96:99], v[212:215], v[56:59]
    ds_read_b128 v[220:223], v33 offset:1024
    v_cvt_pk_bf16_f32 v254, v44, v45
    v_mfma_f32_16x16x32_bf16 v[196:199], v[76:79], v[240:243], 0
    v_cvt_pk_bf16_f32 v255, v46, v47
    v_mfma_f32_16x16x32_bf16 v[192:195], v[76:79], v[236:239], 0
    ds_write_b64 v35, v[254:255] offset:512
    v_mfma_f32_16x16x32_bf16 v[48:51], v[104:107], v[84:87], v[48:51]
    ds_write_b32 v37, v38 offset:32
    v_mfma_f32_16x16x32_bf16 v[52:55], v[112:115], v[84:87], v[52:55]
    ds_read_b128 v[248:251], v33 offset:16
    v_cvt_pk_bf16_f32 v184, v200, v204
    v_mfma_f32_16x16x32_bf16 v[52:55], v[104:107], v[92:95], v[52:55]
    s_waitcnt vmcnt(0)
    v_cvt_pk_bf16_f32 v185, v201, v205
    v_mfma_f32_16x16x32_bf16 v[56:59], v[112:115], v[92:95], v[56:59]
    ds_read_b64 v[212:213], v138 offset:128
    v_cvt_pk_bf16_f32 v186, v202, v206
    v_cvt_pk_bf16_f32 v187, v203, v207
    v_mfma_f32_16x16x32_bf16 v[204:207], v[100:103], v[240:243], 0
    ds_read_b64 v[214:215], v138 offset:136
    v_cvt_pk_bf16_f32 v224, v192, v196
    v_mfma_f32_16x16x32_bf16 v[200:203], v[100:103], v[236:239], 0
    v_cvt_pk_bf16_f32 v225, v193, v197
    v_mfma_f32_16x16x32_bf16 v[48:51], v[120:123], v[108:111], v[48:51]
    v_cvt_pk_bf16_f32 v226, v194, v198
    v_mfma_f32_16x16x32_bf16 v[52:55], v[4:7], v[108:111], v[52:55]
    ds_read_b64 v[84:85], v138 offset:192
    v_cvt_pk_bf16_f32 v227, v195, v199
    v_mfma_f32_16x16x32_bf16 v[52:55], v[120:123], v[116:119], v[52:55]
    ds_read_b64 v[86:87], v138 offset:200
    v_perm_b32 v216, v210, v208, s60
    v_mfma_f32_16x16x32_bf16 v[56:59], v[4:7], v[116:119], v[56:59]
    ds_read_b64 v[92:93], v138 offset:256
    ds_write_b32 v32, v216 offset:2048
    v_mfma_f32_16x16x32_bf16 v[48:51], v[12:15], v[124:127], v[48:51]
    ds_read_b64 v[94:95], v138 offset:264
    v_perm_b32 v216, v210, v208, s61
    v_mfma_f32_16x16x32_bf16 v[52:55], v[20:23], v[124:127], v[52:55]
    ds_read_b64 v[100:101], v138 offset:320
    ds_write_b32 v32, v216 offset:6672
    v_mfma_f32_16x16x32_bf16 v[52:55], v[12:15], v[8:11], v[52:55]
    ds_read_b64 v[102:103], v138 offset:328
    v_perm_b32 v216, v211, v209, s60
    v_mfma_f32_16x16x32_bf16 v[56:59], v[20:23], v[8:11], v[56:59]
    ds_read_b128 v[108:111], v137 offset:1024
    ds_write_b32 v32, v216 offset:11296
    v_mfma_f32_16x16x32_bf16 v[48:51], v[28:31], v[16:19], v[48:51]
    v_perm_b32 v216, v211, v209, s61
    v_mfma_f32_16x16x32_bf16 v[52:55], v[144:147], v[16:19], v[52:55]
    ds_write_b32 v32, v216 offset:15920
    s_waitcnt lgkmcnt(5)
    v_mfma_f32_16x16x32_bf16 v[52:55], v[28:31], v[140:143], v[52:55]
    s_mov_b64 exec, 15
    ds_add_u32 v136, v38 offset:16
    s_mov_b64 exec, -1
    v_mfma_f32_16x16x32_bf16 v[56:59], v[144:147], v[140:143], v[56:59]
    v_cvt_pk_bf16_f32 v76, v200, v204
    v_mfma_f32_16x16x32_bf16 v[48:51], v[152:155], v[148:151], v[48:51]
    v_cvt_pk_bf16_f32 v77, v201, v205
    v_mfma_f32_16x16x32_bf16 v[52:55], v[160:163], v[148:151], v[52:55]
    ds_read_b128 v[116:119], v137 offset:1280
    v_cvt_pk_bf16_f32 v78, v202, v206
    v_mfma_f32_16x16x32_bf16 v[52:55], v[152:155], v[156:159], v[52:55]
    v_cvt_pk_bf16_f32 v79, v203, v207
    v_mfma_f32_16x16x32_bf16 v[56:59], v[160:163], v[156:159], v[56:59]
    v_mfma_f32_16x16x32_bf16 v[48:51], v[168:171], v[164:167], v[48:51]
    ds_read_b32 v132, v37 offset:16
    v_mfma_f32_16x16x32_bf16 v[52:55], v[176:179], v[164:167], v[52:55]
    v_mfma_f32_16x16x32_bf16 v[52:55], v[168:171], v[172:175], v[52:55]
    v_mfma_f32_16x16x32_bf16 v[56:59], v[176:179], v[172:175], v[56:59]
    ds_read_b128 v[124:127], v137 offset:1536
    v_mfma_f32_16x16x32_bf16 v[48:51], v[180:183], v[188:191], v[48:51]
    v_mfma_f32_16x16x32_bf16 v[52:55], v[180:183], v[220:223], v[52:55]
    v_mfma_f32_16x16x32_bf16 v[52:55], v[244:247], v[248:251], v[52:55]
    ds_read_b128 v[8:11], v137 offset:1792
    v_mfma_f32_16x16x32_bf16 v[52:55], v[24:27], v[212:215], v[52:55]
    v_mfma_f32_16x16x32_bf16 v[52:55], v[184:187], v[84:87], v[52:55]
    s_waitcnt lgkmcnt(2)
    v_cmp_ne_u32 vcc, 4, v132
    s_cbranch_vccnz L_spinb
L_backb:
    v_mfma_f32_16x16x32_bf16 v[48:51], v[24:27], v[92:95], v[48:51]
    ds_read_b128 v[16:19], v33 offset:2560
    ds_read_b128 v[140:143], v33 offset:3072
    v_mfma_f32_16x16x32_bf16 v[52:55], v[224:227], v[92:95], v[52:55]
    ds_read_b128 v[148:151], v33 offset:2496
    v_mfma_f32_16x16x32_bf16 v[48:51], v[184:187], v[100:103], v[48:51]
    ds_read_b128 v[156:159], v33 offset:3008
    v_mfma_f32_16x16x32_bf16 v[52:55], v[76:79], v[100:103], v[52:55]
    ds_read_b128 v[164:167], v33 offset:2432
    v_mfma_f32_16x16x32_bf16 v[196:199], v[108:111], v[240:243], 0
    ds_read_b128 v[172:175], v33 offset:2944
    v_mfma_f32_16x16x32_bf16 v[192:195], v[108:111], v[236:239], 0
    ds_read_b128 v[188:191], v33 offset:2368
    s_waitcnt lgkmcnt(5)
    v_mfma_f32_16x16x32_bf16 v[56:59], v[72:75], v[16:19], v[56:59]
    ds_read_b128 v[220:223], v33 offset:2880
    v_mfma_f32_16x16x32_bf16 v[60:63], v[80:83], v[16:19], 0
    ds_read_b128 v[212:215], v33 offset:512
    v_mfma_f32_16x16x32_bf16 v[60:63], v[72:75], v[140:143], v[60:63]
    ds_read_b128 v[84:87], v33 offset:496
    v_cvt_pk_bf16_f32 v248, v192, v196
    v_mfma_f32_16x16x32_bf16 v[64:67], v[80:83], v[140:143], 0
    ds_read_b128 v[92:95], v33 offset:2304
    v_cvt_pk_bf16_f32 v249, v193, v197
    v_mfma_f32_16x16x32_bf16 v[204:207], v[116:119], v[240:243], 0
    ds_read_b128 v[100:103], v33 offset:2816
    v_cvt_pk_bf16_f32 v250, v194, v198
    v_mfma_f32_16x16x32_bf16 v[200:203], v[116:119], v[236:239], 0
    ds_read_b128 v[16:19], v33 offset:1024
    v_cvt_pk_bf16_f32 v251, v195, v199
    s_waitcnt lgkmcnt(5)
    v_mfma_f32_16x16x32_bf16 v[56:59], v[88:91], v[148:151], v[56:59]
    ds_read_b128 v[140:143], v33 offset:1008
    v_cvt_pk_bf16_f32 v252, v48, v49
    v_mfma_f32_16x16x32_bf16 v[60:63], v[96:99], v[148:151], v[60:63]
    ds_read_b128 v[208:211], v33 offset:2240
    v_cvt_pk_bf16_f32 v253, v50, v51
    v_mfma_f32_16x16x32_bf16 v[60:63], v[88:91], v[156:159], v[60:63]
    ds_write_b64 v35, v[252:253] offset:1024
    v_mfma_f32_16x16x32_bf16 v[64:67], v[96:99], v[156:159], v[64:67]
    ds_read_b128 v[216:219], v33 offset:2752
    v_cvt_pk_bf16_f32 v254, v52, v53
    v_mfma_f32_16x16x32_bf16 v[196:199], v[124:127], v[240:243], 0
    v_cvt_pk_bf16_f32 v255, v54, v55
    v_mfma_f32_16x16x32_bf16 v[192:195], v[124:127], v[236:239], 0
    ds_write_b64 v35, v[254:255] offset:1536
    v_mfma_f32_16x16x32_bf16 v[56:59], v[104:107], v[164:167], v[56:59]
    ds_write_b32 v37, v38 offset:48
    v_mfma_f32_16x16x32_bf16 v[60:63], v[112:115], v[164:167], v[60:63]
    ds_read_b128 v[148:151], v33 offset:2176
    v_cvt_pk_bf16_f32 v108, v200, v204
    v_mfma_f32_16x16x32_bf16 v[60:63], v[104:107], v[172:175], v[60:63]
    v_cvt_pk_bf16_f32 v109, v201, v205
    v_mfma_f32_16x16x32_bf16 v[64:67], v[112:115], v[172:175], v[64:67]
    ds_read_b128 v[156:159], v33 offset:2688
    v_cvt_pk_bf16_f32 v110, v202, v206
    v_cvt_pk_bf16_f32 v111, v203, v207
    v_mfma_f32_16x16x32_bf16 v[204:207], v[8:11], v[240:243], 0
    v_cvt_pk_bf16_f32 v116, v192, v196
    v_mfma_f32_16x16x32_bf16 v[200:203], v[8:11], v[236:239], 0
    v_cvt_pk_bf16_f32 v117, v193, v197
    v_mfma_f32_16x16x32_bf16 v[56:59], v[120:123], v[188:191], v[56:59]
    v_cvt_pk_bf16_f32 v118, v194, v198
    v_mfma_f32_16x16x32_bf16 v[60:63], v[4:7], v[188:191], v[60:63]
    ds_read_b128 v[164:167], v33 offset:2112
    v_cvt_pk_bf16_f32 v119, v195, v199
    v_mfma_f32_16x16x32_bf16 v[60:63], v[120:123], v[220:223], v[60:63]
    s_nop 0
    v_cvt_pk_bf16_f32 v124, v200, v204
    v_mfma_f32_16x16x32_bf16 v[64:67], v[4:7], v[220:223], v[64:67]
    ds_read_b128 v[172:175], v33 offset:2624
    v_cvt_pk_bf16_f32 v125, v201, v205
    s_waitcnt lgkmcnt(5)
    v_mfma_f32_16x16x32_bf16 v[196:199], v[212:215], v[232:235], 0
    ds_read_b128 v[8:11], v33 offset:1536
    v_cvt_pk_bf16_f32 v126, v202, v206
    v_mfma_f32_16x16x32_bf16 v[192:195], v[84:87], v[228:231], 0
    v_cvt_pk_bf16_f32 v127, v203, v207
    v_mfma_f32_16x16x32_bf16 v[56:59], v[12:15], v[92:95], v[56:59]
    v_mfma_f32_16x16x32_bf16 v[60:63], v[20:23], v[92:95], v[60:63]
    ds_read_b128 v[220:223], v33 offset:528
    v_mfma_f32_16x16x32_bf16 v[60:63], v[12:15], v[100:103], v[60:63]
    s_nop 2
    v_cvt_pk_bf16_f32 v188, v192, v196
    v_mfma_f32_16x16x32_bf16 v[64:67], v[20:23], v[100:103], v[64:67]
    ds_read_b128 v[212:215], v33 offset:2048
    v_cvt_pk_bf16_f32 v189, v193, v197
    v_mfma_f32_16x16x32_bf16 v[204:207], v[16:19], v[232:235], 0
    ds_read_b128 v[84:87], v33 offset:1040
    v_cvt_pk_bf16_f32 v190, v194, v198
    ds_read_b32 v132, v37
    v_mfma_f32_16x16x32_bf16 v[200:203], v[140:143], v[228:231], 0
    v_cvt_pk_bf16_f32 v191, v195, v199
    v_mfma_f32_16x16x32_bf16 v[56:59], v[28:31], v[208:211], v[56:59]
    v_mfma_f32_16x16x32_bf16 v[60:63], v[144:147], v[208:211], v[60:63]
    ds_read_b64 v[100:101], v138 offset:0
    v_mfma_f32_16x16x32_bf16 v[60:63], v[28:31], v[216:219], v[60:63]
    ds_read_b64 v[102:103], v138 offset:8
    s_nop 1
    v_cvt_pk_bf16_f32 v92, v200, v204
    v_mfma_f32_16x16x32_bf16 v[64:67], v[144:147], v[216:219], v[64:67]
    ds_read_b64 v[16:17], v138 offset:64
    v_cvt_pk_bf16_f32 v93, v201, v205
    s_waitcnt lgkmcnt(5)
    v_mfma_f32_16x16x32_bf16 v[56:59], v[152:155], v[148:151], v[56:59]
    ds_read_b64 v[18:19], v138 offset:72
    v_cvt_pk_bf16_f32 v94, v202, v206
    v_mfma_f32_16x16x32_bf16 v[60:63], v[160:163], v[148:151], v[60:63]
    ds_read_b64 v[140:141], v138 offset:128
    v_cvt_pk_bf16_f32 v95, v203, v207
    v_mfma_f32_16x16x32_bf16 v[60:63], v[152:155], v[156:159], v[60:63]
    ds_read_b64 v[142:143], v138 offset:136
    s_waitcnt lgkmcnt(5)
    v_cmp_ne_u32 vcc, 4, v132
    s_cbranch_vccnz L_spinc
L_backc:
    v_mfma_f32_16x16x32_bf16 v[64:67], v[160:163], v[156:159], v[64:67]
    ds_read_b64 v[208:209], v138 offset:192
    v_mfma_f32_16x16x32_bf16 v[56:59], v[168:171], v[164:167], v[56:59]
    ds_read_b64 v[210:211], v138 offset:200
    v_mfma_f32_16x16x32_bf16 v[60:63], v[176:179], v[164:167], v[60:63]
    ds_read_b64 v[216:217], v138 offset:256
    v_mfma_f32_16x16x32_bf16 v[60:63], v[168:171], v[172:175], v[60:63]
    ds_read_b64 v[218:219], v138 offset:264
    v_mfma_f32_16x16x32_bf16 v[64:67], v[176:179], v[172:175], v[64:67]
    ds_read_b64 v[148:149], v138 offset:320
    v_mfma_f32_16x16x32_bf16 v[56:59], v[180:183], v[8:11], v[56:59]
    ds_read_b64 v[150:151], v138 offset:328
    v_mfma_f32_16x16x32_bf16 v[56:59], v[244:247], v[220:223], v[56:59]
    ds_read2_b32 v[156:157], v36 offset0:32 offset1:33
    v_mfma_f32_16x16x32_bf16 v[60:63], v[180:183], v[212:215], v[60:63]
    ds_read2_b32 v[158:159], v36 offset0:34 offset1:35
    v_mfma_f32_16x16x32_bf16 v[60:63], v[244:247], v[84:87], v[60:63]
    ds_read2_b32 v[164:165], v36 offset0:48 offset1:49
    s_waitcnt lgkmcnt(5)
    v_mfma_f32_16x16x32_bf16 v[56:59], v[24:27], v[100:103], v[56:59]
    ds_read2_b32 v[166:167], v36 offset0:50 offset1:51
    v_mfma_f32_16x16x32_bf16 v[60:63], v[224:227], v[100:103], v[60:63]
    ds_read_b128 v[172:175], v137 offset:2048
    v_mfma_f32_16x16x32_bf16 v[56:59], v[184:187], v[16:19], v[56:59]
    ds_read_b128 v[8:11], v33 offset:3584
    v_mfma_f32_16x16x32_bf16 v[60:63], v[76:79], v[16:19], v[60:63]
    ds_read_b128 v[220:223], v33 offset:4096
    v_mfma_f32_16x16x32_bf16 v[56:59], v[224:227], v[140:143], v[56:59]
    ds_read_b128 v[212:215], v137 offset:2304
    v_mfma_f32_16x16x32_bf16 v[60:63], v[248:251], v[140:143], v[60:63]
    ds_read_b128 v[84:87], v33 offset:3520
    v_mfma_f32_16x16x32_bf16 v[56:59], v[76:79], v[208:211], v[56:59]
    ds_read_b128 v[24:27], v33 offset:4032
    v_mfma_f32_16x16x32_bf16 v[60:63], v[108:111], v[208:211], v[60:63]
    ds_read_b128 v[100:103], v137 offset:2560
    v_mfma_f32_16x16x32_bf16 v[56:59], v[248:251], v[216:219], v[56:59]
    ds_read_b128 v[184:187], v33 offset:3456
    v_mfma_f32_16x16x32_bf16 v[60:63], v[116:119], v[216:219], v[60:63]
    ds_read_b128 v[16:19], v33 offset:3968
    s_waitcnt lgkmcnt(5)
    v_mfma_f32_16x16x32_bf16 v[56:59], v[108:111], v[148:151], v[56:59]
    ds_read_b128 v[224:227], v137 offset:2816
    v_mfma_f32_16x16x32_bf16 v[60:63], v[124:127], v[148:151], v[60:63]
    ds_read_b128 v[140:143], v33 offset:3392
    v_mfma_f32_16x16x32_bf16 v[60:63], v[188:191], v[156:159], v[60:63]
    ds_read_b128 v[76:79], v33 offset:3904
    v_mfma_f32_16x16x32_bf16 v[56:59], v[188:191], v[164:167], v[56:59]
    ds_read_b128 v[208:211], v33 offset:1536
    v_mfma_f32_16x16x32_bf16 v[60:63], v[92:95], v[164:167], v[60:63]
    ds_read_b128 v[216:219], v33 offset:1520
    v_mfma_f32_16x16x32_bf16 v[196:199], v[172:175], v[240:243], 0
    v_mfma_f32_16x16x32_bf16 v[192:195], v[172:175], v[236:239], 0
    v_mfma_f32_16x16x32_bf16 v[64:67], v[72:75], v[8:11], v[64:67]
    v_mfma_f32_16x16x32_bf16 v[68:71], v[80:83], v[8:11], 0
    ds_read_b128 v[156:159], v33 offset:3328
    v_mfma_f32_16x16x32_bf16 v[68:71], v[72:75], v[220:223], v[68:71]
    ds_read_b128 v[164:167], v33 offset:3840
    s_nop 2
    v_cvt_pk_bf16_f32 v148, v192, v196
    v_mfma_f32_16x16x32_bf16 v[204:207], v[212:215], v[240:243], 0
    ds_read_b128 v[172:175], v33 offset:2048
    v_cvt_pk_bf16_f32 v149, v193, v197
    v_mfma_f32_16x16x32_bf16 v[200:203], v[212:215], v[236:239], 0
    ds_read_b128 v[80:83], v33 offset:2032
    v_cvt_pk_bf16_f32 v150, v194, v198
    s_waitcnt lgkmcnt(5)
    v_mfma_f32_16x16x32_bf16 v[64:67], v[88:91], v[84:87], v[64:67]
    v_cvt_pk_bf16_f32 v151, v195, v199
    v_mfma_f32_16x16x32_bf16 v[68:71], v[96:99], v[84:87], v[68:71]
    ds_read_b128 v[72:75], v33 offset:3264
    v_cvt_pk_bf16_f32 v252, v56, v57
    v_mfma_f32_16x16x32_bf16 v[68:71], v[88:91], v[24:27], v[68:71]
    ds_read_b128 v[220:223], v33 offset:3776
    v_cvt_pk_bf16_f32 v253, v58, v59
    v_mfma_f32_16x16x32_bf16 v[196:199], v[100:103], v[240:243], 0
    ds_read_b128 v[212:215], v33 offset:3200
    ds_write_b64 v35, v[252:253] offset:2048
    v_mfma_f32_16x16x32_bf16 v[192:195], v[100:103], v[236:239], 0
    ds_read_b128 v[96:99], v33 offset:3712
    v_cvt_pk_bf16_f32 v254, v60, v61
    v_mfma_f32_16x16x32_bf16 v[64:67], v[104:107], v[184:187], v[64:67]
    v_cvt_pk_bf16_f32 v255, v62, v63
    v_mfma_f32_16x16x32_bf16 v[68:71], v[112:115], v[184:187], v[68:71]
    ds_read_b128 v[88:91], v33 offset:3136
    ds_write_b64 v35, v[254:255] offset:2560
    v_mfma_f32_16x16x32_bf16 v[68:71], v[104:107], v[16:19], v[68:71]
    ds_read_b128 v[24:27], v33 offset:3648
    ds_write_b32 v37, v38 offset:64
    v_cvt_pk_bf16_f32 v8, v200, v204
    v_cvt_pk_bf16_f32 v9, v201, v205
    v_cvt_pk_bf16_f32 v10, v202, v206
    v_cvt_pk_bf16_f32 v11, v203, v207
    v_mfma_f32_16x16x32_bf16 v[204:207], v[224:227], v[240:243], 0
    ds_read_b128 v[100:103], v33 offset:2560
    v_cvt_pk_bf16_f32 v84, v192, v196
    v_mfma_f32_16x16x32_bf16 v[200:203], v[224:227], v[236:239], 0
    ds_read_b128 v[112:115], v33 offset:1552
    v_cvt_pk_bf16_f32 v85, v193, v197
    v_mfma_f32_16x16x32_bf16 v[64:67], v[120:123], v[140:143], v[64:67]
    v_cvt_pk_bf16_f32 v86, v194, v198
    v_mfma_f32_16x16x32_bf16 v[68:71], v[4:7], v[140:143], v[68:71]
    ds_read_b128 v[104:107], v33 offset:3072
    v_cvt_pk_bf16_f32 v87, v195, v199
    v_mfma_f32_16x16x32_bf16 v[68:71], v[120:123], v[76:79], v[68:71]
    ds_read_b128 v[16:19], v33 offset:2064
    v_cvt_pk_bf16_f32 v184, v200, v204
    v_mfma_f32_16x16x32_bf16 v[196:199], v[208:211], v[232:235], 0
    ds_read_b64 v[224:225], v138 offset:0
    v_cvt_pk_bf16_f32 v185, v201, v205
    s_waitcnt lgkmcnt(5)
    v_mfma_f32_16x16x32_bf16 v[192:195], v[216:219], v[228:231], 0
    ds_read_b64 v[226:227], v138 offset:8
    v_cvt_pk_bf16_f32 v186, v202, v206
    v_mfma_f32_16x16x32_bf16 v[64:67], v[12:15], v[156:159], v[64:67]
    ds_read_b64 v[4:5], v138 offset:64
    v_cvt_pk_bf16_f32 v187, v203, v207
    v_mfma_f32_16x16x32_bf16 v[68:71], v[20:23], v[156:159], v[68:71]
    ds_read_b64 v[6:7], v138 offset:72
    v_mfma_f32_16x16x32_bf16 v[68:71], v[12:15], v[164:167], v[68:71]
    ds_read_b64 v[120:121], v138 offset:128
    v_cvt_pk_bf16_f32 v140, v192, v196
    v_mfma_f32_16x16x32_bf16 v[204:207], v[172:175], v[232:235], 0
    ds_read_b64 v[122:123], v138 offset:136
    v_cvt_pk_bf16_f32 v141, v193, v197
    v_mfma_f32_16x16x32_bf16 v[200:203], v[80:83], v[228:231], 0
    ds_read_b64 v[76:77], v138 offset:192
    v_cvt_pk_bf16_f32 v142, v194, v198
    v_mfma_f32_16x16x32_bf16 v[64:67], v[28:31], v[72:75], v[64:67]
    ds_read_b64 v[78:79], v138 offset:200
    v_cvt_pk_bf16_f32 v143, v195, v199
    v_mfma_f32_16x16x32_bf16 v[68:71], v[144:147], v[72:75], v[68:71]
    ds_read_b64 v[216:217], v138 offset:256
    v_mfma_f32_16x16x32_bf16 v[68:71], v[28:31], v[220:223], v[68:71]
    ds_read_b64 v[218:219], v138 offset:264
    v_cvt_pk_bf16_f32 v208, v200, v204
    v_mfma_f32_16x16x32_bf16 v[64:67], v[152:155], v[212:215], v[64:67]
    ds_read_b64 v[20:21], v138 offset:320
    v_cvt_pk_bf16_f32 v209, v201, v205
    v_mfma_f32_16x16x32_bf16 v[68:71], v[160:163], v[212:215], v[68:71]
    ds_read_b64 v[22:23], v138 offset:328
    v_cvt_pk_bf16_f32 v210, v202, v206
    v_mfma_f32_16x16x32_bf16 v[68:71], v[152:155], v[96:99], v[68:71]
    ds_read2_b32 v[156:157], v36 offset0:0 offset1:1
    v_cvt_pk_bf16_f32 v211, v203, v207
    v_mfma_f32_16x16x32_bf16 v[64:67], v[168:171], v[88:91], v[64:67]
    ds_read2_b32 v[158:159], v36 offset0:2 offset1:3
    v_mfma_f32_16x16x32_bf16 v[68:71], v[176:179], v[88:91], v[68:71]
    ds_read2_b32 v[12:13], v36 offset0:16 offset1:17
    v_mfma_f32_16x16x32_bf16 v[68:71], v[168:171], v[24:27], v[68:71]
    ds_read2_b32 v[14:15], v36 offset0:18 offset1:19
    s_waitcnt lgkmcnt(5)
    v_mfma_f32_16x16x32_bf16 v[64:67], v[180:183], v[100:103], v[64:67]
    ds_read2_b32 v[164:165], v36 offset0:32 offset1:33
    v_mfma_f32_16x16x32_bf16 v[64:67], v[244:247], v[112:115], v[64:67]
    ds_read2_b32 v[166:167], v36 offset0:34 offset1:35
    v_mfma_f32_16x16x32_bf16 v[68:71], v[180:183], v[104:107], v[68:71]
    ds_read2_b32 v[172:173], v36 offset0:48 offset1:49
    v_mfma_f32_16x16x32_bf16 v[68:71], v[244:247], v[16:19], v[68:71]
    ds_read2_b32 v[174:175], v36 offset0:50 offset1:51
    v_mfma_f32_16x16x32_bf16 v[64:67], v[248:251], v[224:227], v[64:67]
    v_mfma_f32_16x16x32_bf16 v[68:71], v[116:119], v[224:227], v[68:71]
    v_mfma_f32_16x16x32_bf16 v[64:67], v[108:111], v[4:7], v[64:67]
    v_mfma_f32_16x16x32_bf16 v[68:71], v[124:127], v[4:7], v[68:71]
    v_mfma_f32_16x16x32_bf16 v[64:67], v[116:119], v[120:123], v[64:67]
    v_mfma_f32_16x16x32_bf16 v[68:71], v[148:151], v[120:123], v[68:71]
    v_mfma_f32_16x16x32_bf16 v[64:67], v[124:127], v[76:79], v[64:67]
    v_mfma_f32_16x16x32_bf16 v[68:71], v[8:11], v[76:79], v[68:71]
    v_mfma_f32_16x16x32_bf16 v[64:67], v[148:151], v[216:219], v[64:67]
    v_mfma_f32_16x16x32_bf16 v[68:71], v[84:87], v[216:219], v[68:71]
    s_waitcnt lgkmcnt(5)
    v_mfma_f32_16x16x32_bf16 v[64:67], v[8:11], v[20:23], v[64:67]
    v_mfma_f32_16x16x32_bf16 v[68:71], v[184:187], v[20:23], v[68:71]
    v_mfma_f32_16x16x32_bf16 v[68:71], v[188:191], v[156:159], v[68:71]
    s_waitcnt lgkmcnt(4)
    v_mfma_f32_16x16x32_bf16 v[64:67], v[188:191], v[12:15], v[64:67]
    v_mfma_f32_16x16x32_bf16 v[68:71], v[92:95], v[12:15], v[68:71]
    s_waitcnt lgkmcnt(2)
    v_mfma_f32_16x16x32_bf16 v[64:67], v[92:95], v[164:167], v[64:67]
    v_mfma_f32_16x16x32_bf16 v[68:71], v[140:143], v[164:167], v[68:71]
    s_waitcnt lgkmcnt(0)
    v_mfma_f32_16x16x32_bf16 v[64:67], v[140:143], v[172:175], v[64:67]
    v_mfma_f32_16x16x32_bf16 v[68:71], v[208:211], v[172:175], v[68:71]
    s_nop 6
    v_cvt_pk_bf16_f32 v252, v64, v65
    v_cvt_pk_bf16_f32 v253, v66, v67
    ds_write_b64 v35, v[252:253] offset:3072
    v_cvt_pk_bf16_f32 v254, v68, v69
    v_cvt_pk_bf16_f32 v255, v70, v71
    ds_write_b64 v35, v[254:255] offset:3584
    ds_write_b32 v37, v38 offset:80
    s_endpgm
L_spinb:
    ds_read_b32 v132, v37 offset:16
    s_waitcnt lgkmcnt(0)
    v_cmp_ne_u32 vcc, 4, v132
    s_cbranch_vccnz L_spinb
    s_branch L_backb
L_spinc:
    ds_read_b32 v132, v37
    s_waitcnt lgkmcnt(0)
    v_cmp_ne_u32 vcc, 4, v132
    s_cbranch_vccnz L_spinc
    s_branch L_backc
L_Bfin:
    s_setprio 1
    v_and_b32 v33, 255, v0
    v_lshlrev_b32 v36, 13, v33
    v_lshlrev_b32 v33, 3, v33
    v_add_u32 v34, 116736, v33
    s_mov_b32 s40, s34
    s_mov_b32 s41, s35
    s_mov_b32 s42, 4194304
    s_mov_b32 s43, 0x20000
    s_add_u32 s48, s47, 1024
    s_add_u32 s49, s47, 5120
    s_add_u32 s50, s47, 2098176
    s_add_u32 s51, s47, 2102272
    s_cmp_ge_u32 s3, 6
    s_cselect_b32 s44, 16, 0
    s_add_u32 s44, s44, 134656
    v_lshl_add_u32 v134, v3, 2, s44
    v_mov_b32 v135, 1
    s_waitcnt vmcnt(0)
    v_perm_b32 v108, v190, v188, s60
    ds_write_b32 v32, v108 offset:1024
    v_perm_b32 v109, v190, v188, s61
    ds_write_b32 v32, v109 offset:5648
    v_perm_b32 v110, v191, v189, s60
    ds_write_b32 v32, v110 offset:10272
    v_perm_b32 v111, v191, v189, s61
    ds_write_b32 v32, v111 offset:14896
    s_mov_b64 exec, 15
    ds_add_u32 v136, v135
    s_mov_b64 exec, -1
L_spiny:
    s_sleep 4
    ds_read_b32 v40, v134 offset:32
    s_waitcnt lgkmcnt(0)
    v_cmp_eq_u32 vcc, 0, v40
    s_cbranch_vccnz L_spiny
    ds_read_b64 v[100:101], v34 offset:0
    ds_read_b64 v[102:103], v34 offset:4096
    ds_read_b64 v[104:105], v34 offset:8192
    ds_read_b64 v[106:107], v34 offset:12288
    s_waitcnt lgkmcnt(2)
    v_perm_b32 v116, v102, v100, s60
    s_waitcnt lgkmcnt(0)
    v_perm_b32 v117, v106, v104, s60
    buffer_store_dwordx2 v[116:117], v36, s[40:43], s48 offen offset:0
    v_perm_b32 v118, v102, v100, s61
    v_perm_b32 v119, v106, v104, s61
    buffer_store_dwordx2 v[118:119], v36, s[40:43], s48 offen offset:2048
    v_perm_b32 v120, v103, v101, s60
    v_perm_b32 v121, v107, v105, s60
    buffer_store_dwordx2 v[120:121], v36, s[40:43], s49 offen offset:0
    v_perm_b32 v122, v103, v101, s61
    v_perm_b32 v123, v107, v105, s61
    buffer_store_dwordx2 v[122:123], v36, s[40:43], s49 offen offset:2048
L_spinq:
    s_sleep 2
    ds_read_b32 v40, v134 offset:64
    s_waitcnt lgkmcnt(0)
    v_cmp_eq_u32 vcc, 0, v40
    s_cbranch_vccnz L_spinq
    ds_read_b64 v[100:101], v34 offset:2048
    ds_read_b64 v[102:103], v34 offset:6144
    ds_read_b64 v[104:105], v34 offset:10240
    ds_read_b64 v[106:107], v34 offset:14336
    s_waitcnt lgkmcnt(2)
    v_perm_b32 v116, v102, v100, s60
    s_waitcnt lgkmcnt(0)
    v_perm_b32 v117, v106, v104, s60
    buffer_store_dwordx2 v[116:117], v36, s[40:43], s50 offen offset:0
    v_perm_b32 v118, v102, v100, s61
    v_perm_b32 v119, v106, v104, s61
    buffer_store_dwordx2 v[118:119], v36, s[40:43], s50 offen offset:2048
    v_perm_b32 v120, v103, v101, s60
    v_perm_b32 v121, v107, v105, s60
    buffer_store_dwordx2 v[120:121], v36, s[40:43], s51 offen offset:0
    v_perm_b32 v122, v103, v101, s61
    v_perm_b32 v123, v107, v105, s61
    buffer_store_dwordx2 v[122:123], v36, s[40:43], s51 offen offset:2048
    s_endpgm
L_end:
.section .rodata,"a"
.p2align 6
.amdhsa_kernel concat_heads__spectral_gfnet__ssm_conv_s4__prompt_kernel
  .amdhsa_next_free_vgpr 256
  .amdhsa_next_free_sgpr 102
  .amdhsa_accum_offset 256
  .amdhsa_group_segment_fixed_size 0
  .amdhsa_kernarg_size 120
  .amdhsa_user_sgpr_count 2
  .amdhsa_user_sgpr_kernarg_segment_ptr 1
  .amdhsa_system_sgpr_workgroup_id_x 1
.end_amdhsa_kernel
```
